```python
import torch

def _softmax(x, axis=-1):
    return torch.softmax(x, dim=axis)
def _gelu(x):
    return torch.nn.functional.gelu(x, approximate="tanh")
def _silu(x):
    return torch.nn.functional.silu(x)
def _sigmoid(x):
    return torch.sigmoid(x)
def _layernorm(x, axis=-1, eps=1e-5):
    m = x.mean(dim=axis, keepdim=True)
    v = x.var(dim=axis, keepdim=True, unbiased=False)
    return (x - m) / torch.sqrt(v + eps)
def _scatter_add(tgt, idx, src, axis=0):
    return tgt.clone().index_add_(axis, idx, src)
def _segment_sum(src, seg, n):
    out = torch.zeros((n,) + src.shape[1:], dtype=src.dtype)
    return out.index_add_(0, seg, src)
def _pad(x, pw):
    flat = tuple(v for pair in reversed(pw) for v in pair)
    return torch.nn.functional.pad(x, flat)

kernel_name = 'gated_mix__mha_block_cached__geglu_ffn__decode'

def setup_inputs():

    _w = (lambda a: (lambda t: t.to(torch.bfloat16) if t.is_floating_point() else t)(torch.as_tensor(a)))
    def _A_setup():
        B, Sq, D = 8, 1, 1024
        H, Sk, Dh = 32, 4096, 128
        return {
            "x": _w((lambda *s: torch.randn(*s, dtype=torch.bfloat16) * 0.05)(B, Sq, D)),
            "k_cache": _w((lambda *s: torch.randn(*s, dtype=torch.bfloat16) * 6.4)(B, H, Sk, Dh)),
            "v_cache": _w((lambda *s: torch.randn(*s, dtype=torch.bfloat16) * 0.4)(B, H, Sk, Dh)),
            "wq": _w((lambda *s: torch.randn(*s, dtype=torch.bfloat16) * 6.4)(D, H * Dh) * (D ** -0.5)),
            "wo": _w((lambda *s: torch.randn(*s, dtype=torch.bfloat16) * 0.4)(H * Dh, D) * ((H * Dh) ** -0.5)),
        }
    _A_in = _A_setup()

    def _B_setup():
        B, S, D, F = 8, 1, 1024, 3584
        return {
            "x": _w((lambda *s: torch.randn(*s, dtype=torch.bfloat16) * 0.05)(B, S, D)),
            "w_gate": _w((lambda *s: torch.randn(*s, dtype=torch.bfloat16) * 0.05)(D, F)),
            "w_up": _w((lambda *s: torch.randn(*s, dtype=torch.bfloat16) * 0.05)(D, F)),
            "w_down": _w((lambda *s: torch.randn(*s, dtype=torch.bfloat16) * 0.05)(F, D)),
        }
    _B_in = _B_setup()

    return {
        "A_x": _A_in["x"],
        "A_k_cache": _A_in["k_cache"],
        "A_v_cache": _A_in["v_cache"],
        "A_wq": _A_in["wq"],
        "A_wo": _A_in["wo"],
        "B_x": _B_in["x"],
        "B_w_gate": _B_in["w_gate"],
        "B_w_up": _B_in["w_up"],
        "B_w_down": _B_in["w_down"],
        "gate_w": _w((lambda *s: torch.randn(*s, dtype=torch.bfloat16) * 0.05)(1024) * 16.0),
    }

def reference(A_x, A_k_cache, A_v_cache, A_wq, A_wo, B_x, B_w_gate, B_w_up, B_w_down, gate_w):
    def _A_ref(x, k_cache, v_cache, wq, wo):
        B, Sq, D = x.shape
        H, Dh = 32, 128
        q = (lambda x, *d: x.permute(*d))((x @ wq).reshape(B, Sq, H, Dh), 0, 2, 1, 3)
        scores = torch.einsum("bhqd,bhkd->bhqk", q, k_cache) * (Dh ** -0.5)
        p = _softmax(scores, axis=-1)
        o = torch.einsum("bhqk,bhkd->bhqd", p, v_cache)
        return (lambda x, *d: x.permute(*d))(o, 0, 2, 1, 3).reshape(B, Sq, H * Dh) @ wo

    def _B_ref(x, w_gate, w_up, w_down):
        return (_gelu(x @ w_gate) * (x @ w_up)) @ w_down

    x = A_x
    g = _sigmoid((x * gate_w).sum(-1, keepdims=True))
    a = _A_ref(x, A_k_cache, A_v_cache, A_wq, A_wo)
    b = _B_ref(x, B_w_gate, B_w_up, B_w_down)
    return g * a + (1 - g) * b
```

```asm
; @launch grid=(256,1,1) block=(512,1,1) lds=159744
.amdgcn_target "amdgcn-amd-amdhsa--gfx950"
.text
.globl gated_mix__mha_block_cached__geglu_ffn__decode_kernel
.p2align 8
.type gated_mix__mha_block_cached__geglu_ffn__decode_kernel,@function
gated_mix__mha_block_cached__geglu_ffn__decode_kernel:
    s_cmp_ge_u32 s2, 256
    s_cbranch_scc1 L_end
    s_load_dwordx16 s[16:31], s[0:1], 0
    s_load_dwordx8 s[32:39], s[0:1], 64
    s_load_dwordx2 s[40:41], s[0:1], 96
    v_lshrrev_b32 v1, 6, v0
    v_and_b32 v2, 63, v0
    v_readfirstlane_b32 s3, v1
    s_and_b32 s10, s2, 7
    s_lshr_b32 s11, s2, 3
    s_and_b32 s6, s11, 3
    s_lshl_b32 s7, s10, 2
    s_add_u32 s6, s6, s7
    s_lshr_b32 s7, s11, 2
    s_mul_i32 s15, s10, 7
    s_add_u32 s15, s15, s7
    s_and_b32 s99, s11, 3
    s_mov_b32 s8, 0xffff0000
    v_and_b32 v3, 15, v2
    v_lshrrev_b32 v4, 4, v2
    s_cmp_ge_u32 s3, 4
    s_cbranch_scc1 L_aux
    s_memrealtime s[82:83]
    s_lshl_b32 s9, s7, 5
    s_add_u32 s9, s9, s6
    s_lshl_b32 s10, s9, 20
    v_lshlrev_b32 v5, 4, v2
    s_mul_i32 s12, s3, 16384
    v_add_u32 v5, s12, v5
    s_mov_b32 s52, 0
    s_mov_b32 s54, 8192
    s_mov_b32 s56, 65536
    s_mov_b32 s58, 73728
    s_mov_b32 s53, 4096
    s_mov_b32 s55, 12288
    s_mov_b32 s57, 69632
    s_mov_b32 s59, 77824
    v_mov_b32 v6, 0
    v_mov_b32 v7, 0
    ds_write_b64 v6, v[6:7] offset:256
    ds_write_b64 v6, v[6:7] offset:264
    s_waitcnt lgkmcnt(0)
    s_add_u32 s44, s18, s10
    s_addc_u32 s45, s19, 0
    s_mov_b32 s46, 0x100000
    s_mov_b32 s47, 0x00020000
    s_add_u32 s48, s20, s10
    s_addc_u32 s49, s21, 0
    s_mov_b32 s50, 0x100000
    s_mov_b32 s51, 0x00020000
    s_add_u32 s68, s18, s10
    s_addc_u32 s69, s19, 0
    s_mov_b32 s70, 0x100000
    s_mov_b32 s71, 0x00020000
    s_barrier
    buffer_load_dwordx4 v[124:127], v5, s[44:47], s52 offen offset:0 nt
    buffer_load_dwordx4 v[128:131], v5, s[44:47], s52 offen offset:1024 nt
    buffer_load_dwordx4 v[132:135], v5, s[44:47], s52 offen offset:2048 nt
    buffer_load_dwordx4 v[136:139], v5, s[44:47], s52 offen offset:3072 nt
    buffer_load_dwordx4 v[140:143], v5, s[44:47], s53 offen offset:0 nt
    buffer_load_dwordx4 v[144:147], v5, s[44:47], s53 offen offset:1024 nt
    buffer_load_dwordx4 v[148:151], v5, s[44:47], s53 offen offset:2048 nt
    buffer_load_dwordx4 v[152:155], v5, s[44:47], s53 offen offset:3072 nt
    buffer_load_dwordx4 v[156:159], v5, s[44:47], s54 offen offset:0 nt
    buffer_load_dwordx4 v[160:163], v5, s[44:47], s54 offen offset:1024 nt
    buffer_load_dwordx4 v[164:167], v5, s[44:47], s54 offen offset:2048 nt
    buffer_load_dwordx4 v[168:171], v5, s[44:47], s54 offen offset:3072 nt
    buffer_load_dwordx4 v[172:175], v5, s[44:47], s55 offen offset:0 nt
    buffer_load_dwordx4 v[176:179], v5, s[44:47], s55 offen offset:1024 nt
    buffer_load_dwordx4 v[180:183], v5, s[44:47], s55 offen offset:2048 nt
    buffer_load_dwordx4 v[184:187], v5, s[44:47], s55 offen offset:3072 nt
    s_mov_b32 s52, s56
    s_mov_b32 s53, s57
    s_mov_b32 s54, s58
    s_mov_b32 s55, s59
    s_add_u32 s56, s56, 0x10000
    s_add_u32 s57, s57, 0x10000
    s_add_u32 s58, s58, 0x10000
    s_add_u32 s59, s59, 0x10000
    buffer_load_dwordx4 v[60:63], v5, s[44:47], s52 offen offset:0 nt
    buffer_load_dwordx4 v[64:67], v5, s[44:47], s52 offen offset:1024 nt
    buffer_load_dwordx4 v[68:71], v5, s[44:47], s52 offen offset:2048 nt
    buffer_load_dwordx4 v[72:75], v5, s[44:47], s52 offen offset:3072 nt
    buffer_load_dwordx4 v[76:79], v5, s[44:47], s53 offen offset:0 nt
    buffer_load_dwordx4 v[80:83], v5, s[44:47], s53 offen offset:1024 nt
    buffer_load_dwordx4 v[84:87], v5, s[44:47], s53 offen offset:2048 nt
    buffer_load_dwordx4 v[88:91], v5, s[44:47], s53 offen offset:3072 nt
    buffer_load_dwordx4 v[92:95], v5, s[44:47], s54 offen offset:0 nt
    buffer_load_dwordx4 v[96:99], v5, s[44:47], s54 offen offset:1024 nt
    buffer_load_dwordx4 v[100:103], v5, s[44:47], s54 offen offset:2048 nt
    buffer_load_dwordx4 v[104:107], v5, s[44:47], s54 offen offset:3072 nt
    buffer_load_dwordx4 v[108:111], v5, s[44:47], s55 offen offset:0 nt
    buffer_load_dwordx4 v[112:115], v5, s[44:47], s55 offen offset:1024 nt
    buffer_load_dwordx4 v[116:119], v5, s[44:47], s55 offen offset:2048 nt
    buffer_load_dwordx4 v[120:123], v5, s[44:47], s55 offen offset:3072 nt
    v_mov_b32 v32, 0
    v_mov_b32 v33, 0
    v_mov_b32 v34, 0
    v_mov_b32 v35, 0
    v_mov_b32 v36, 0
    v_mov_b32 v37, 0
    v_mov_b32 v38, 0
    v_mov_b32 v39, 0
    v_mov_b32 v40, 0xff61b1e6
    v_mov_b32 v41, 0
    s_mov_b32 s13, 0x3db504f3
    s_mov_b32 s14, 0x3fb8aa3b
    s_mov_b32 s15, 1
    s_lshl_b32 s12, s3, 12
    s_add_u32 s63, s12, 143360
    v_lshrrev_b32 v43, 2, v2
    v_lshlrev_b32 v43, 4, v43
    v_add_u32 v43, s63, v43
    v_lshlrev_b32 v6, 4, v3
L_qwait:
    ds_read_b32 v12, v7 offset:264
    s_waitcnt lgkmcnt(0)
    v_readfirstlane_b32 s12, v12
    s_nop 1
    s_cmp_lg_u32 s12, 0
    s_cbranch_scc1 L_qdone
    s_sleep 1
    s_branch L_qwait
L_qdone:
    ds_read_b128 v[8:11], v6 offset:0
    v_lshlrev_b32 v6, 5, v3
    s_waitcnt lgkmcnt(0)
    s_waitcnt vmcnt(31)
    v_dot2_f32_bf16 v16, v124, v8, 0
    v_dot2_f32_bf16 v16, v125, v9, v16
    v_dot2_f32_bf16 v16, v126, v10, v16
    v_dot2_f32_bf16 v16, v127, v11, v16
    s_nop 0
    s_waitcnt vmcnt(30)
    v_dot2_f32_bf16 v17, v128, v8, 0
    v_dot2_f32_bf16 v17, v129, v9, v17
    v_dot2_f32_bf16 v17, v130, v10, v17
    v_dot2_f32_bf16 v17, v131, v11, v17
    s_nop 0
    s_waitcnt vmcnt(29)
    v_dot2_f32_bf16 v18, v132, v8, 0
    v_dot2_f32_bf16 v18, v133, v9, v18
    v_dot2_f32_bf16 v18, v134, v10, v18
    v_dot2_f32_bf16 v18, v135, v11, v18
    s_nop 0
    s_waitcnt vmcnt(28)
    v_dot2_f32_bf16 v19, v136, v8, 0
    v_dot2_f32_bf16 v19, v137, v9, v19
    v_dot2_f32_bf16 v19, v138, v10, v19
    v_dot2_f32_bf16 v19, v139, v11, v19
    s_nop 0
    v_add_f32_dpp v16, v16, v16 row_ror:8 row_mask:0xf bank_mask:0x3
    v_add_f32_dpp v16, v17, v17 row_ror:8 row_mask:0xf bank_mask:0xc
    s_waitcnt vmcnt(27)
    v_dot2_f32_bf16 v20, v140, v8, 0
    v_dot2_f32_bf16 v20, v141, v9, v20
    v_dot2_f32_bf16 v20, v142, v10, v20
    v_dot2_f32_bf16 v20, v143, v11, v20
    s_nop 0
    s_waitcnt vmcnt(26)
    v_dot2_f32_bf16 v21, v144, v8, 0
    v_dot2_f32_bf16 v21, v145, v9, v21
    v_dot2_f32_bf16 v21, v146, v10, v21
    v_dot2_f32_bf16 v21, v147, v11, v21
    s_nop 0
    v_add_f32_dpp v18, v18, v18 row_ror:8 row_mask:0xf bank_mask:0x3
    v_add_f32_dpp v18, v19, v19 row_ror:8 row_mask:0xf bank_mask:0xc
    s_waitcnt vmcnt(25)
    v_dot2_f32_bf16 v22, v148, v8, 0
    v_dot2_f32_bf16 v22, v149, v9, v22
    v_dot2_f32_bf16 v22, v150, v10, v22
    v_dot2_f32_bf16 v22, v151, v11, v22
    s_nop 0
    s_waitcnt vmcnt(24)
    v_dot2_f32_bf16 v23, v152, v8, 0
    v_dot2_f32_bf16 v23, v153, v9, v23
    v_dot2_f32_bf16 v23, v154, v10, v23
    v_dot2_f32_bf16 v23, v155, v11, v23
    s_nop 0
    v_add_f32_dpp v20, v20, v20 row_ror:8 row_mask:0xf bank_mask:0x3
    v_add_f32_dpp v20, v21, v21 row_ror:8 row_mask:0xf bank_mask:0xc
    v_add_f32_dpp v16, v16, v16 row_ror:12 row_mask:0xf bank_mask:0x5
    v_add_f32_dpp v16, v18, v18 row_ror:4 row_mask:0xf bank_mask:0xa
    v_add_f32_dpp v22, v22, v22 row_ror:8 row_mask:0xf bank_mask:0x3
    v_add_f32_dpp v22, v23, v23 row_ror:8 row_mask:0xf bank_mask:0xc
    v_add_f32_dpp v20, v20, v20 row_ror:12 row_mask:0xf bank_mask:0x5
    v_add_f32_dpp v16, v16, v16 quad_perm:[1,0,3,2] row_mask:0xf bank_mask:0xf
    v_add_f32_dpp v20, v22, v22 row_ror:4 row_mask:0xf bank_mask:0xa
    s_nop 0
    v_add_f32_dpp v16, v16, v16 quad_perm:[2,3,0,1] row_mask:0xf bank_mask:0xf
    v_add_f32_dpp v20, v20, v20 quad_perm:[1,0,3,2] row_mask:0xf bank_mask:0xf
    s_nop 1
    v_add_f32_dpp v20, v20, v20 quad_perm:[2,3,0,1] row_mask:0xf bank_mask:0xf
    v_cvt_pk_bf16_f32 v44, v16, v20
    v_lshlrev_b32 v12, 16, v44
    v_and_b32 v13, s8, v44
    v_mul_f32 v12, s13, v12
    v_mul_f32 v13, s13, v13
    v_cvt_pk_bf16_f32 v44, v12, v13
    v_lshlrev_b32 v12, 16, v44
    v_and_b32 v13, s8, v44
    v_max3_f32 v40, v12, v13, v40
    s_waitcnt vmcnt(23)
    v_dot2_f32_bf16 v16, v156, v8, 0
    v_dot2_f32_bf16 v16, v157, v9, v16
    v_dot2_f32_bf16 v16, v158, v10, v16
    v_dot2_f32_bf16 v16, v159, v11, v16
    s_nop 0
    s_waitcnt vmcnt(22)
    v_dot2_f32_bf16 v17, v160, v8, 0
    v_dot2_f32_bf16 v17, v161, v9, v17
    v_dot2_f32_bf16 v17, v162, v10, v17
    v_dot2_f32_bf16 v17, v163, v11, v17
    s_nop 0
    s_waitcnt vmcnt(21)
    v_dot2_f32_bf16 v18, v164, v8, 0
    v_dot2_f32_bf16 v18, v165, v9, v18
    v_dot2_f32_bf16 v18, v166, v10, v18
    v_dot2_f32_bf16 v18, v167, v11, v18
    s_nop 0
    s_waitcnt vmcnt(20)
    v_dot2_f32_bf16 v19, v168, v8, 0
    v_dot2_f32_bf16 v19, v169, v9, v19
    v_dot2_f32_bf16 v19, v170, v10, v19
    v_dot2_f32_bf16 v19, v171, v11, v19
    s_nop 0
    v_add_f32_dpp v16, v16, v16 row_ror:8 row_mask:0xf bank_mask:0x3
    v_add_f32_dpp v16, v17, v17 row_ror:8 row_mask:0xf bank_mask:0xc
    s_waitcnt vmcnt(19)
    v_dot2_f32_bf16 v20, v172, v8, 0
    v_dot2_f32_bf16 v20, v173, v9, v20
    v_dot2_f32_bf16 v20, v174, v10, v20
    v_dot2_f32_bf16 v20, v175, v11, v20
    s_nop 0
    s_waitcnt vmcnt(18)
    v_dot2_f32_bf16 v21, v176, v8, 0
    v_dot2_f32_bf16 v21, v177, v9, v21
    v_dot2_f32_bf16 v21, v178, v10, v21
    v_dot2_f32_bf16 v21, v179, v11, v21
    s_nop 0
    v_add_f32_dpp v18, v18, v18 row_ror:8 row_mask:0xf bank_mask:0x3
    v_add_f32_dpp v18, v19, v19 row_ror:8 row_mask:0xf bank_mask:0xc
    s_waitcnt vmcnt(17)
    v_dot2_f32_bf16 v22, v180, v8, 0
    v_dot2_f32_bf16 v22, v181, v9, v22
    v_dot2_f32_bf16 v22, v182, v10, v22
    v_dot2_f32_bf16 v22, v183, v11, v22
    s_nop 0
    s_waitcnt vmcnt(16)
    v_dot2_f32_bf16 v23, v184, v8, 0
    v_dot2_f32_bf16 v23, v185, v9, v23
    v_dot2_f32_bf16 v23, v186, v10, v23
    v_dot2_f32_bf16 v23, v187, v11, v23
    s_nop 0
    v_add_f32_dpp v20, v20, v20 row_ror:8 row_mask:0xf bank_mask:0x3
    v_add_f32_dpp v20, v21, v21 row_ror:8 row_mask:0xf bank_mask:0xc
    v_add_f32_dpp v16, v16, v16 row_ror:12 row_mask:0xf bank_mask:0x5
    v_add_f32_dpp v16, v18, v18 row_ror:4 row_mask:0xf bank_mask:0xa
    v_add_f32_dpp v22, v22, v22 row_ror:8 row_mask:0xf bank_mask:0x3
    v_add_f32_dpp v22, v23, v23 row_ror:8 row_mask:0xf bank_mask:0xc
    v_add_f32_dpp v20, v20, v20 row_ror:12 row_mask:0xf bank_mask:0x5
    v_add_f32_dpp v16, v16, v16 quad_perm:[1,0,3,2] row_mask:0xf bank_mask:0xf
    v_add_f32_dpp v20, v22, v22 row_ror:4 row_mask:0xf bank_mask:0xa
    s_nop 0
    v_add_f32_dpp v16, v16, v16 quad_perm:[2,3,0,1] row_mask:0xf bank_mask:0xf
    v_add_f32_dpp v20, v20, v20 quad_perm:[1,0,3,2] row_mask:0xf bank_mask:0xf
    s_nop 1
    v_add_f32_dpp v20, v20, v20 quad_perm:[2,3,0,1] row_mask:0xf bank_mask:0xf
    v_cvt_pk_bf16_f32 v44, v16, v20
    v_lshlrev_b32 v14, 16, v44
    v_and_b32 v15, s8, v44
    v_mul_f32 v14, s13, v14
    v_mul_f32 v15, s13, v15
    v_cvt_pk_bf16_f32 v44, v14, v15
    v_lshlrev_b32 v14, 16, v44
    v_and_b32 v15, s8, v44
    v_max3_f32 v40, v14, v15, v40
    ds_write_b128 v43, v[12:15]
    v_add_u32 v43, 0x100, v43
    s_add_u32 s62, s82, 1175
    s_waitcnt vmcnt(15)
    v_dot2_f32_bf16 v16, v60, v8, 0
    v_dot2_f32_bf16 v16, v61, v9, v16
    v_dot2_f32_bf16 v16, v62, v10, v16
    v_dot2_f32_bf16 v16, v63, v11, v16
    s_nop 0
    s_waitcnt vmcnt(14)
    v_dot2_f32_bf16 v17, v64, v8, 0
    v_dot2_f32_bf16 v17, v65, v9, v17
    v_dot2_f32_bf16 v17, v66, v10, v17
    v_dot2_f32_bf16 v17, v67, v11, v17
    s_nop 0
    s_waitcnt vmcnt(13)
    v_dot2_f32_bf16 v18, v68, v8, 0
    v_dot2_f32_bf16 v18, v69, v9, v18
    v_dot2_f32_bf16 v18, v70, v10, v18
    v_dot2_f32_bf16 v18, v71, v11, v18
    s_nop 0
    s_waitcnt vmcnt(12)
    v_dot2_f32_bf16 v19, v72, v8, 0
    v_dot2_f32_bf16 v19, v73, v9, v19
    v_dot2_f32_bf16 v19, v74, v10, v19
    v_dot2_f32_bf16 v19, v75, v11, v19
    s_nop 0
    v_add_f32_dpp v16, v16, v16 row_ror:8 row_mask:0xf bank_mask:0x3
    v_add_f32_dpp v16, v17, v17 row_ror:8 row_mask:0xf bank_mask:0xc
    s_waitcnt vmcnt(11)
    v_dot2_f32_bf16 v20, v76, v8, 0
    v_dot2_f32_bf16 v20, v77, v9, v20
    v_dot2_f32_bf16 v20, v78, v10, v20
    v_dot2_f32_bf16 v20, v79, v11, v20
    s_nop 0
    s_waitcnt vmcnt(10)
    v_dot2_f32_bf16 v21, v80, v8, 0
    v_dot2_f32_bf16 v21, v81, v9, v21
    v_dot2_f32_bf16 v21, v82, v10, v21
    v_dot2_f32_bf16 v21, v83, v11, v21
    s_nop 0
    v_add_f32_dpp v18, v18, v18 row_ror:8 row_mask:0xf bank_mask:0x3
    v_add_f32_dpp v18, v19, v19 row_ror:8 row_mask:0xf bank_mask:0xc
    s_waitcnt vmcnt(9)
    v_dot2_f32_bf16 v22, v84, v8, 0
    v_dot2_f32_bf16 v22, v85, v9, v22
    v_dot2_f32_bf16 v22, v86, v10, v22
    v_dot2_f32_bf16 v22, v87, v11, v22
    buffer_load_dwordx4 v[60:63], v5, s[68:71], s56 offen offset:0 nt
    s_waitcnt vmcnt(9)
    v_dot2_f32_bf16 v23, v88, v8, 0
    v_dot2_f32_bf16 v23, v89, v9, v23
    v_dot2_f32_bf16 v23, v90, v10, v23
    v_dot2_f32_bf16 v23, v91, v11, v23
    buffer_load_dwordx4 v[64:67], v5, s[68:71], s56 offen offset:1024 nt
    v_add_f32_dpp v20, v20, v20 row_ror:8 row_mask:0xf bank_mask:0x3
    v_add_f32_dpp v20, v21, v21 row_ror:8 row_mask:0xf bank_mask:0xc
    v_add_f32_dpp v16, v16, v16 row_ror:12 row_mask:0xf bank_mask:0x5
    v_add_f32_dpp v16, v18, v18 row_ror:4 row_mask:0xf bank_mask:0xa
    v_add_f32_dpp v22, v22, v22 row_ror:8 row_mask:0xf bank_mask:0x3
    v_add_f32_dpp v22, v23, v23 row_ror:8 row_mask:0xf bank_mask:0xc
    v_add_f32_dpp v20, v20, v20 row_ror:12 row_mask:0xf bank_mask:0x5
    v_add_f32_dpp v16, v16, v16 quad_perm:[1,0,3,2] row_mask:0xf bank_mask:0xf
    v_add_f32_dpp v20, v22, v22 row_ror:4 row_mask:0xf bank_mask:0xa
    s_nop 0
    v_add_f32_dpp v16, v16, v16 quad_perm:[2,3,0,1] row_mask:0xf bank_mask:0xf
    v_add_f32_dpp v20, v20, v20 quad_perm:[1,0,3,2] row_mask:0xf bank_mask:0xf
    s_nop 1
    v_add_f32_dpp v20, v20, v20 quad_perm:[2,3,0,1] row_mask:0xf bank_mask:0xf
    v_cvt_pk_bf16_f32 v44, v16, v20
    v_lshlrev_b32 v12, 16, v44
    v_and_b32 v13, s8, v44
    v_mul_f32 v12, s13, v12
    v_mul_f32 v13, s13, v13
    v_cvt_pk_bf16_f32 v44, v12, v13
    v_lshlrev_b32 v12, 16, v44
    v_and_b32 v13, s8, v44
    v_max3_f32 v40, v12, v13, v40
    s_memrealtime s[80:81]
    s_waitcnt vmcnt(9)
    v_dot2_f32_bf16 v16, v92, v8, 0
    v_dot2_f32_bf16 v16, v93, v9, v16
    v_dot2_f32_bf16 v16, v94, v10, v16
    v_dot2_f32_bf16 v16, v95, v11, v16
    buffer_load_dwordx4 v[68:71], v5, s[68:71], s56 offen offset:2048 nt
    s_waitcnt vmcnt(9)
    v_dot2_f32_bf16 v17, v96, v8, 0
    v_dot2_f32_bf16 v17, v97, v9, v17
    v_dot2_f32_bf16 v17, v98, v10, v17
    v_dot2_f32_bf16 v17, v99, v11, v17
    buffer_load_dwordx4 v[72:75], v5, s[68:71], s56 offen offset:3072 nt
    s_waitcnt vmcnt(9)
    v_dot2_f32_bf16 v18, v100, v8, 0
    v_dot2_f32_bf16 v18, v101, v9, v18
    v_dot2_f32_bf16 v18, v102, v10, v18
    v_dot2_f32_bf16 v18, v103, v11, v18
    buffer_load_dwordx4 v[76:79], v5, s[68:71], s57 offen offset:0 nt
    s_waitcnt vmcnt(9)
    v_dot2_f32_bf16 v19, v104, v8, 0
    v_dot2_f32_bf16 v19, v105, v9, v19
    v_dot2_f32_bf16 v19, v106, v10, v19
    v_dot2_f32_bf16 v19, v107, v11, v19
    buffer_load_dwordx4 v[80:83], v5, s[68:71], s57 offen offset:1024 nt
    v_add_f32_dpp v16, v16, v16 row_ror:8 row_mask:0xf bank_mask:0x3
    v_add_f32_dpp v16, v17, v17 row_ror:8 row_mask:0xf bank_mask:0xc
    s_waitcnt vmcnt(9)
    v_dot2_f32_bf16 v20, v108, v8, 0
    v_dot2_f32_bf16 v20, v109, v9, v20
    v_dot2_f32_bf16 v20, v110, v10, v20
    v_dot2_f32_bf16 v20, v111, v11, v20
    buffer_load_dwordx4 v[84:87], v5, s[68:71], s57 offen offset:2048 nt
    s_waitcnt vmcnt(9)
    v_dot2_f32_bf16 v21, v112, v8, 0
    v_dot2_f32_bf16 v21, v113, v9, v21
    v_dot2_f32_bf16 v21, v114, v10, v21
    v_dot2_f32_bf16 v21, v115, v11, v21
    buffer_load_dwordx4 v[88:91], v5, s[68:71], s57 offen offset:3072 nt
    v_add_f32_dpp v18, v18, v18 row_ror:8 row_mask:0xf bank_mask:0x3
    v_add_f32_dpp v18, v19, v19 row_ror:8 row_mask:0xf bank_mask:0xc
    s_waitcnt vmcnt(9)
    v_dot2_f32_bf16 v22, v116, v8, 0
    v_dot2_f32_bf16 v22, v117, v9, v22
    v_dot2_f32_bf16 v22, v118, v10, v22
    v_dot2_f32_bf16 v22, v119, v11, v22
    buffer_load_dwordx4 v[92:95], v5, s[68:71], s58 offen offset:0 nt
    s_waitcnt vmcnt(9)
    v_dot2_f32_bf16 v23, v120, v8, 0
    v_dot2_f32_bf16 v23, v121, v9, v23
    v_dot2_f32_bf16 v23, v122, v10, v23
    v_dot2_f32_bf16 v23, v123, v11, v23
    buffer_load_dwordx4 v[96:99], v5, s[68:71], s58 offen offset:1024 nt
    v_add_f32_dpp v20, v20, v20 row_ror:8 row_mask:0xf bank_mask:0x3
    v_add_f32_dpp v20, v21, v21 row_ror:8 row_mask:0xf bank_mask:0xc
    v_add_f32_dpp v16, v16, v16 row_ror:12 row_mask:0xf bank_mask:0x5
    v_add_f32_dpp v16, v18, v18 row_ror:4 row_mask:0xf bank_mask:0xa
    v_add_f32_dpp v22, v22, v22 row_ror:8 row_mask:0xf bank_mask:0x3
    v_add_f32_dpp v22, v23, v23 row_ror:8 row_mask:0xf bank_mask:0xc
    v_add_f32_dpp v20, v20, v20 row_ror:12 row_mask:0xf bank_mask:0x5
    v_add_f32_dpp v16, v16, v16 quad_perm:[1,0,3,2] row_mask:0xf bank_mask:0xf
    v_add_f32_dpp v20, v22, v22 row_ror:4 row_mask:0xf bank_mask:0xa
    s_nop 0
    v_add_f32_dpp v16, v16, v16 quad_perm:[2,3,0,1] row_mask:0xf bank_mask:0xf
    v_add_f32_dpp v20, v20, v20 quad_perm:[1,0,3,2] row_mask:0xf bank_mask:0xf
    s_nop 1
    v_add_f32_dpp v20, v20, v20 quad_perm:[2,3,0,1] row_mask:0xf bank_mask:0xf
    v_cvt_pk_bf16_f32 v44, v16, v20
    v_lshlrev_b32 v14, 16, v44
    v_and_b32 v15, s8, v44
    v_mul_f32 v14, s13, v14
    v_mul_f32 v15, s13, v15
    v_cvt_pk_bf16_f32 v44, v14, v15
    v_lshlrev_b32 v14, 16, v44
    v_and_b32 v15, s8, v44
    v_max3_f32 v40, v14, v15, v40
    ds_write_b128 v43, v[12:15]
    v_add_u32 v43, 0x100, v43
    s_mov_b32 s52, s56
    s_mov_b32 s53, s57
    s_mov_b32 s54, s58
    s_mov_b32 s55, s59
    s_add_u32 s56, s56, 0x10000
    s_add_u32 s57, s57, 0x10000
    s_add_u32 s58, s58, 0x10000
    s_add_u32 s59, s59, 0x10000
    s_add_u32 s15, s15, 1
    s_waitcnt lgkmcnt(0)
    s_cmp_ge_u32 s15, 15
    s_cbranch_scc1 L_kv1
    s_sub_u32 s12, s80, s62
    s_add_u32 s62, s62, 225
    s_cmp_lt_i32 s12, 0
    s_cbranch_scc1 L_Kt10
    s_branch L_Ks1
L_Kt01:
    buffer_load_dwordx4 v[80:83], v5, s[44:47], s53 offen offset:1024 nt
    buffer_load_dwordx4 v[84:87], v5, s[44:47], s53 offen offset:2048 nt
    buffer_load_dwordx4 v[88:91], v5, s[44:47], s53 offen offset:3072 nt
    buffer_load_dwordx4 v[92:95], v5, s[44:47], s54 offen offset:0 nt
    buffer_load_dwordx4 v[96:99], v5, s[44:47], s54 offen offset:1024 nt
L_Ks1:
    s_waitcnt vmcnt(9)
    v_dot2_f32_bf16 v16, v60, v8, 0
    v_dot2_f32_bf16 v16, v61, v9, v16
    v_dot2_f32_bf16 v16, v62, v10, v16
    v_dot2_f32_bf16 v16, v63, v11, v16
    buffer_load_dwordx4 v[100:103], v5, s[44:47], s54 offen offset:2048 nt
    s_waitcnt vmcnt(9)
    v_dot2_f32_bf16 v17, v64, v8, 0
    v_dot2_f32_bf16 v17, v65, v9, v17
    v_dot2_f32_bf16 v17, v66, v10, v17
    v_dot2_f32_bf16 v17, v67, v11, v17
    buffer_load_dwordx4 v[104:107], v5, s[44:47], s54 offen offset:3072 nt
    s_waitcnt vmcnt(9)
    v_dot2_f32_bf16 v18, v68, v8, 0
    v_dot2_f32_bf16 v18, v69, v9, v18
    v_dot2_f32_bf16 v18, v70, v10, v18
    v_dot2_f32_bf16 v18, v71, v11, v18
    buffer_load_dwordx4 v[108:111], v5, s[44:47], s55 offen offset:0 nt
    s_waitcnt vmcnt(9)
    v_dot2_f32_bf16 v19, v72, v8, 0
    v_dot2_f32_bf16 v19, v73, v9, v19
    v_dot2_f32_bf16 v19, v74, v10, v19
    v_dot2_f32_bf16 v19, v75, v11, v19
    buffer_load_dwordx4 v[112:115], v5, s[44:47], s55 offen offset:1024 nt
    v_add_f32_dpp v16, v16, v16 row_ror:8 row_mask:0xf bank_mask:0x3
    v_add_f32_dpp v16, v17, v17 row_ror:8 row_mask:0xf bank_mask:0xc
    s_waitcnt vmcnt(9)
    v_dot2_f32_bf16 v20, v76, v8, 0
    v_dot2_f32_bf16 v20, v77, v9, v20
    v_dot2_f32_bf16 v20, v78, v10, v20
    v_dot2_f32_bf16 v20, v79, v11, v20
    buffer_load_dwordx4 v[116:119], v5, s[44:47], s55 offen offset:2048 nt
    s_waitcnt vmcnt(9)
    v_dot2_f32_bf16 v21, v80, v8, 0
    v_dot2_f32_bf16 v21, v81, v9, v21
    v_dot2_f32_bf16 v21, v82, v10, v21
    v_dot2_f32_bf16 v21, v83, v11, v21
    buffer_load_dwordx4 v[120:123], v5, s[44:47], s55 offen offset:3072 nt
    v_add_f32_dpp v18, v18, v18 row_ror:8 row_mask:0xf bank_mask:0x3
    v_add_f32_dpp v18, v19, v19 row_ror:8 row_mask:0xf bank_mask:0xc
    s_waitcnt vmcnt(9)
    v_dot2_f32_bf16 v22, v84, v8, 0
    v_dot2_f32_bf16 v22, v85, v9, v22
    v_dot2_f32_bf16 v22, v86, v10, v22
    v_dot2_f32_bf16 v22, v87, v11, v22
    buffer_load_dwordx4 v[60:63], v5, s[68:71], s56 offen offset:0 nt
    s_waitcnt vmcnt(9)
    v_dot2_f32_bf16 v23, v88, v8, 0
    v_dot2_f32_bf16 v23, v89, v9, v23
    v_dot2_f32_bf16 v23, v90, v10, v23
    v_dot2_f32_bf16 v23, v91, v11, v23
    buffer_load_dwordx4 v[64:67], v5, s[68:71], s56 offen offset:1024 nt
    v_add_f32_dpp v20, v20, v20 row_ror:8 row_mask:0xf bank_mask:0x3
    v_add_f32_dpp v20, v21, v21 row_ror:8 row_mask:0xf bank_mask:0xc
    v_add_f32_dpp v16, v16, v16 row_ror:12 row_mask:0xf bank_mask:0x5
    v_add_f32_dpp v16, v18, v18 row_ror:4 row_mask:0xf bank_mask:0xa
    v_add_f32_dpp v22, v22, v22 row_ror:8 row_mask:0xf bank_mask:0x3
    v_add_f32_dpp v22, v23, v23 row_ror:8 row_mask:0xf bank_mask:0xc
    v_add_f32_dpp v20, v20, v20 row_ror:12 row_mask:0xf bank_mask:0x5
    v_add_f32_dpp v16, v16, v16 quad_perm:[1,0,3,2] row_mask:0xf bank_mask:0xf
    v_add_f32_dpp v20, v22, v22 row_ror:4 row_mask:0xf bank_mask:0xa
    s_nop 0
    v_add_f32_dpp v16, v16, v16 quad_perm:[2,3,0,1] row_mask:0xf bank_mask:0xf
    v_add_f32_dpp v20, v20, v20 quad_perm:[1,0,3,2] row_mask:0xf bank_mask:0xf
    s_nop 1
    v_add_f32_dpp v20, v20, v20 quad_perm:[2,3,0,1] row_mask:0xf bank_mask:0xf
    v_cvt_pk_bf16_f32 v44, v16, v20
    v_lshlrev_b32 v12, 16, v44
    v_and_b32 v13, s8, v44
    v_mul_f32 v12, s13, v12
    v_mul_f32 v13, s13, v13
    v_cvt_pk_bf16_f32 v44, v12, v13
    v_lshlrev_b32 v12, 16, v44
    v_and_b32 v13, s8, v44
    v_max3_f32 v40, v12, v13, v40
    s_memrealtime s[80:81]
    s_waitcnt vmcnt(9)
    v_dot2_f32_bf16 v16, v92, v8, 0
    v_dot2_f32_bf16 v16, v93, v9, v16
    v_dot2_f32_bf16 v16, v94, v10, v16
    v_dot2_f32_bf16 v16, v95, v11, v16
    buffer_load_dwordx4 v[68:71], v5, s[68:71], s56 offen offset:2048 nt
    s_waitcnt vmcnt(9)
    v_dot2_f32_bf16 v17, v96, v8, 0
    v_dot2_f32_bf16 v17, v97, v9, v17
    v_dot2_f32_bf16 v17, v98, v10, v17
    v_dot2_f32_bf16 v17, v99, v11, v17
    buffer_load_dwordx4 v[72:75], v5, s[68:71], s56 offen offset:3072 nt
    s_waitcnt vmcnt(9)
    v_dot2_f32_bf16 v18, v100, v8, 0
    v_dot2_f32_bf16 v18, v101, v9, v18
    v_dot2_f32_bf16 v18, v102, v10, v18
    v_dot2_f32_bf16 v18, v103, v11, v18
    buffer_load_dwordx4 v[76:79], v5, s[68:71], s57 offen offset:0 nt
    s_waitcnt vmcnt(9)
    v_dot2_f32_bf16 v19, v104, v8, 0
    v_dot2_f32_bf16 v19, v105, v9, v19
    v_dot2_f32_bf16 v19, v106, v10, v19
    v_dot2_f32_bf16 v19, v107, v11, v19
    buffer_load_dwordx4 v[80:83], v5, s[68:71], s57 offen offset:1024 nt
    v_add_f32_dpp v16, v16, v16 row_ror:8 row_mask:0xf bank_mask:0x3
    v_add_f32_dpp v16, v17, v17 row_ror:8 row_mask:0xf bank_mask:0xc
    s_waitcnt vmcnt(9)
    v_dot2_f32_bf16 v20, v108, v8, 0
    v_dot2_f32_bf16 v20, v109, v9, v20
    v_dot2_f32_bf16 v20, v110, v10, v20
    v_dot2_f32_bf16 v20, v111, v11, v20
    buffer_load_dwordx4 v[84:87], v5, s[68:71], s57 offen offset:2048 nt
    s_waitcnt vmcnt(9)
    v_dot2_f32_bf16 v21, v112, v8, 0
    v_dot2_f32_bf16 v21, v113, v9, v21
    v_dot2_f32_bf16 v21, v114, v10, v21
    v_dot2_f32_bf16 v21, v115, v11, v21
    buffer_load_dwordx4 v[88:91], v5, s[68:71], s57 offen offset:3072 nt
    v_add_f32_dpp v18, v18, v18 row_ror:8 row_mask:0xf bank_mask:0x3
    v_add_f32_dpp v18, v19, v19 row_ror:8 row_mask:0xf bank_mask:0xc
    s_waitcnt vmcnt(9)
    v_dot2_f32_bf16 v22, v116, v8, 0
    v_dot2_f32_bf16 v22, v117, v9, v22
    v_dot2_f32_bf16 v22, v118, v10, v22
    v_dot2_f32_bf16 v22, v119, v11, v22
    buffer_load_dwordx4 v[92:95], v5, s[68:71], s58 offen offset:0 nt
    s_waitcnt vmcnt(9)
    v_dot2_f32_bf16 v23, v120, v8, 0
    v_dot2_f32_bf16 v23, v121, v9, v23
    v_dot2_f32_bf16 v23, v122, v10, v23
    v_dot2_f32_bf16 v23, v123, v11, v23
    buffer_load_dwordx4 v[96:99], v5, s[68:71], s58 offen offset:1024 nt
    v_add_f32_dpp v20, v20, v20 row_ror:8 row_mask:0xf bank_mask:0x3
    v_add_f32_dpp v20, v21, v21 row_ror:8 row_mask:0xf bank_mask:0xc
    v_add_f32_dpp v16, v16, v16 row_ror:12 row_mask:0xf bank_mask:0x5
    v_add_f32_dpp v16, v18, v18 row_ror:4 row_mask:0xf bank_mask:0xa
    v_add_f32_dpp v22, v22, v22 row_ror:8 row_mask:0xf bank_mask:0x3
    v_add_f32_dpp v22, v23, v23 row_ror:8 row_mask:0xf bank_mask:0xc
    v_add_f32_dpp v20, v20, v20 row_ror:12 row_mask:0xf bank_mask:0x5
    v_add_f32_dpp v16, v16, v16 quad_perm:[1,0,3,2] row_mask:0xf bank_mask:0xf
    v_add_f32_dpp v20, v22, v22 row_ror:4 row_mask:0xf bank_mask:0xa
    s_nop 0
    v_add_f32_dpp v16, v16, v16 quad_perm:[2,3,0,1] row_mask:0xf bank_mask:0xf
    v_add_f32_dpp v20, v20, v20 quad_perm:[1,0,3,2] row_mask:0xf bank_mask:0xf
    s_nop 1
    v_add_f32_dpp v20, v20, v20 quad_perm:[2,3,0,1] row_mask:0xf bank_mask:0xf
    v_cvt_pk_bf16_f32 v44, v16, v20
    v_lshlrev_b32 v14, 16, v44
    v_and_b32 v15, s8, v44
    v_mul_f32 v14, s13, v14
    v_mul_f32 v15, s13, v15
    v_cvt_pk_bf16_f32 v44, v14, v15
    v_lshlrev_b32 v14, 16, v44
    v_and_b32 v15, s8, v44
    v_max3_f32 v40, v14, v15, v40
    ds_write_b128 v43, v[12:15]
    v_add_u32 v43, 0x100, v43
    s_mov_b32 s52, s56
    s_mov_b32 s53, s57
    s_mov_b32 s54, s58
    s_mov_b32 s55, s59
    s_add_u32 s56, s56, 0x10000
    s_add_u32 s57, s57, 0x10000
    s_add_u32 s58, s58, 0x10000
    s_add_u32 s59, s59, 0x10000
    s_add_u32 s15, s15, 1
    s_waitcnt lgkmcnt(0)
    s_cmp_ge_u32 s15, 15
    s_cbranch_scc1 L_kv1
    s_sub_u32 s12, s80, s62
    s_add_u32 s62, s62, 225
    s_cmp_lt_i32 s12, 0
    s_cbranch_scc1 L_Kt10
    s_branch L_Ks1
L_Kt10:
    s_waitcnt vmcnt(9)
    v_dot2_f32_bf16 v16, v60, v8, 0
    v_dot2_f32_bf16 v16, v61, v9, v16
    v_dot2_f32_bf16 v16, v62, v10, v16
    v_dot2_f32_bf16 v16, v63, v11, v16
    s_nop 0
    s_waitcnt vmcnt(8)
    v_dot2_f32_bf16 v17, v64, v8, 0
    v_dot2_f32_bf16 v17, v65, v9, v17
    v_dot2_f32_bf16 v17, v66, v10, v17
    v_dot2_f32_bf16 v17, v67, v11, v17
    s_nop 0
    s_waitcnt vmcnt(7)
    v_dot2_f32_bf16 v18, v68, v8, 0
    v_dot2_f32_bf16 v18, v69, v9, v18
    v_dot2_f32_bf16 v18, v70, v10, v18
    v_dot2_f32_bf16 v18, v71, v11, v18
    s_nop 0
    s_waitcnt vmcnt(6)
    v_dot2_f32_bf16 v19, v72, v8, 0
    v_dot2_f32_bf16 v19, v73, v9, v19
    v_dot2_f32_bf16 v19, v74, v10, v19
    v_dot2_f32_bf16 v19, v75, v11, v19
    s_nop 0
    v_add_f32_dpp v16, v16, v16 row_ror:8 row_mask:0xf bank_mask:0x3
    v_add_f32_dpp v16, v17, v17 row_ror:8 row_mask:0xf bank_mask:0xc
    s_waitcnt vmcnt(5)
    v_dot2_f32_bf16 v20, v76, v8, 0
    v_dot2_f32_bf16 v20, v77, v9, v20
    v_dot2_f32_bf16 v20, v78, v10, v20
    v_dot2_f32_bf16 v20, v79, v11, v20
    s_nop 0
    s_waitcnt vmcnt(4)
    v_dot2_f32_bf16 v21, v80, v8, 0
    v_dot2_f32_bf16 v21, v81, v9, v21
    v_dot2_f32_bf16 v21, v82, v10, v21
    v_dot2_f32_bf16 v21, v83, v11, v21
    buffer_load_dwordx4 v[100:103], v5, s[44:47], s54 offen offset:2048 nt
    v_add_f32_dpp v18, v18, v18 row_ror:8 row_mask:0xf bank_mask:0x3
    v_add_f32_dpp v18, v19, v19 row_ror:8 row_mask:0xf bank_mask:0xc
    s_waitcnt vmcnt(4)
    v_dot2_f32_bf16 v22, v84, v8, 0
    v_dot2_f32_bf16 v22, v85, v9, v22
    v_dot2_f32_bf16 v22, v86, v10, v22
    v_dot2_f32_bf16 v22, v87, v11, v22
    buffer_load_dwordx4 v[104:107], v5, s[44:47], s54 offen offset:3072 nt
    s_waitcnt vmcnt(4)
    v_dot2_f32_bf16 v23, v88, v8, 0
    v_dot2_f32_bf16 v23, v89, v9, v23
    v_dot2_f32_bf16 v23, v90, v10, v23
    v_dot2_f32_bf16 v23, v91, v11, v23
    buffer_load_dwordx4 v[108:111], v5, s[44:47], s55 offen offset:0 nt
    v_add_f32_dpp v20, v20, v20 row_ror:8 row_mask:0xf bank_mask:0x3
    v_add_f32_dpp v20, v21, v21 row_ror:8 row_mask:0xf bank_mask:0xc
    v_add_f32_dpp v16, v16, v16 row_ror:12 row_mask:0xf bank_mask:0x5
    v_add_f32_dpp v16, v18, v18 row_ror:4 row_mask:0xf bank_mask:0xa
    v_add_f32_dpp v22, v22, v22 row_ror:8 row_mask:0xf bank_mask:0x3
    v_add_f32_dpp v22, v23, v23 row_ror:8 row_mask:0xf bank_mask:0xc
    v_add_f32_dpp v20, v20, v20 row_ror:12 row_mask:0xf bank_mask:0x5
    v_add_f32_dpp v16, v16, v16 quad_perm:[1,0,3,2] row_mask:0xf bank_mask:0xf
    v_add_f32_dpp v20, v22, v22 row_ror:4 row_mask:0xf bank_mask:0xa
    s_nop 0
    v_add_f32_dpp v16, v16, v16 quad_perm:[2,3,0,1] row_mask:0xf bank_mask:0xf
    v_add_f32_dpp v20, v20, v20 quad_perm:[1,0,3,2] row_mask:0xf bank_mask:0xf
    s_nop 1
    v_add_f32_dpp v20, v20, v20 quad_perm:[2,3,0,1] row_mask:0xf bank_mask:0xf
    v_cvt_pk_bf16_f32 v44, v16, v20
    v_lshlrev_b32 v12, 16, v44
    v_and_b32 v13, s8, v44
    v_mul_f32 v12, s13, v12
    v_mul_f32 v13, s13, v13
    v_cvt_pk_bf16_f32 v44, v12, v13
    v_lshlrev_b32 v12, 16, v44
    v_and_b32 v13, s8, v44
    v_max3_f32 v40, v12, v13, v40
    s_memrealtime s[80:81]
    s_waitcnt vmcnt(4)
    v_dot2_f32_bf16 v16, v92, v8, 0
    v_dot2_f32_bf16 v16, v93, v9, v16
    v_dot2_f32_bf16 v16, v94, v10, v16
    v_dot2_f32_bf16 v16, v95, v11, v16
    buffer_load_dwordx4 v[112:115], v5, s[44:47], s55 offen offset:1024 nt
    s_waitcnt vmcnt(4)
    v_dot2_f32_bf16 v17, v96, v8, 0
    v_dot2_f32_bf16 v17, v97, v9, v17
    v_dot2_f32_bf16 v17, v98, v10, v17
    v_dot2_f32_bf16 v17, v99, v11, v17
    buffer_load_dwordx4 v[116:119], v5, s[44:47], s55 offen offset:2048 nt
    s_waitcnt vmcnt(4)
    v_dot2_f32_bf16 v18, v100, v8, 0
    v_dot2_f32_bf16 v18, v101, v9, v18
    v_dot2_f32_bf16 v18, v102, v10, v18
    v_dot2_f32_bf16 v18, v103, v11, v18
    buffer_load_dwordx4 v[120:123], v5, s[44:47], s55 offen offset:3072 nt
    s_waitcnt vmcnt(4)
    v_dot2_f32_bf16 v19, v104, v8, 0
    v_dot2_f32_bf16 v19, v105, v9, v19
    v_dot2_f32_bf16 v19, v106, v10, v19
    v_dot2_f32_bf16 v19, v107, v11, v19
    buffer_load_dwordx4 v[60:63], v5, s[68:71], s56 offen offset:0 nt
    v_add_f32_dpp v16, v16, v16 row_ror:8 row_mask:0xf bank_mask:0x3
    v_add_f32_dpp v16, v17, v17 row_ror:8 row_mask:0xf bank_mask:0xc
    s_waitcnt vmcnt(4)
    v_dot2_f32_bf16 v20, v108, v8, 0
    v_dot2_f32_bf16 v20, v109, v9, v20
    v_dot2_f32_bf16 v20, v110, v10, v20
    v_dot2_f32_bf16 v20, v111, v11, v20
    buffer_load_dwordx4 v[64:67], v5, s[68:71], s56 offen offset:1024 nt
    s_waitcnt vmcnt(4)
    v_dot2_f32_bf16 v21, v112, v8, 0
    v_dot2_f32_bf16 v21, v113, v9, v21
    v_dot2_f32_bf16 v21, v114, v10, v21
    v_dot2_f32_bf16 v21, v115, v11, v21
    buffer_load_dwordx4 v[68:71], v5, s[68:71], s56 offen offset:2048 nt
    v_add_f32_dpp v18, v18, v18 row_ror:8 row_mask:0xf bank_mask:0x3
    v_add_f32_dpp v18, v19, v19 row_ror:8 row_mask:0xf bank_mask:0xc
    s_waitcnt vmcnt(4)
    v_dot2_f32_bf16 v22, v116, v8, 0
    v_dot2_f32_bf16 v22, v117, v9, v22
    v_dot2_f32_bf16 v22, v118, v10, v22
    v_dot2_f32_bf16 v22, v119, v11, v22
    buffer_load_dwordx4 v[72:75], v5, s[68:71], s56 offen offset:3072 nt
    s_waitcnt vmcnt(4)
    v_dot2_f32_bf16 v23, v120, v8, 0
    v_dot2_f32_bf16 v23, v121, v9, v23
    v_dot2_f32_bf16 v23, v122, v10, v23
    v_dot2_f32_bf16 v23, v123, v11, v23
    buffer_load_dwordx4 v[76:79], v5, s[68:71], s57 offen offset:0 nt
    v_add_f32_dpp v20, v20, v20 row_ror:8 row_mask:0xf bank_mask:0x3
    v_add_f32_dpp v20, v21, v21 row_ror:8 row_mask:0xf bank_mask:0xc
    v_add_f32_dpp v16, v16, v16 row_ror:12 row_mask:0xf bank_mask:0x5
    v_add_f32_dpp v16, v18, v18 row_ror:4 row_mask:0xf bank_mask:0xa
    v_add_f32_dpp v22, v22, v22 row_ror:8 row_mask:0xf bank_mask:0x3
    v_add_f32_dpp v22, v23, v23 row_ror:8 row_mask:0xf bank_mask:0xc
    v_add_f32_dpp v20, v20, v20 row_ror:12 row_mask:0xf bank_mask:0x5
    v_add_f32_dpp v16, v16, v16 quad_perm:[1,0,3,2] row_mask:0xf bank_mask:0xf
    v_add_f32_dpp v20, v22, v22 row_ror:4 row_mask:0xf bank_mask:0xa
    s_nop 0
    v_add_f32_dpp v16, v16, v16 quad_perm:[2,3,0,1] row_mask:0xf bank_mask:0xf
    v_add_f32_dpp v20, v20, v20 quad_perm:[1,0,3,2] row_mask:0xf bank_mask:0xf
    s_nop 1
    v_add_f32_dpp v20, v20, v20 quad_perm:[2,3,0,1] row_mask:0xf bank_mask:0xf
    v_cvt_pk_bf16_f32 v44, v16, v20
    v_lshlrev_b32 v14, 16, v44
    v_and_b32 v15, s8, v44
    v_mul_f32 v14, s13, v14
    v_mul_f32 v15, s13, v15
    v_cvt_pk_bf16_f32 v44, v14, v15
    v_lshlrev_b32 v14, 16, v44
    v_and_b32 v15, s8, v44
    v_max3_f32 v40, v14, v15, v40
    ds_write_b128 v43, v[12:15]
    v_add_u32 v43, 0x100, v43
    s_mov_b32 s52, s56
    s_mov_b32 s53, s57
    s_mov_b32 s54, s58
    s_mov_b32 s55, s59
    s_add_u32 s56, s56, 0x10000
    s_add_u32 s57, s57, 0x10000
    s_add_u32 s58, s58, 0x10000
    s_add_u32 s59, s59, 0x10000
    s_add_u32 s15, s15, 1
    s_waitcnt lgkmcnt(0)
    s_cmp_ge_u32 s15, 15
    s_cbranch_scc1 L_kv0
    s_sub_u32 s12, s80, s62
    s_add_u32 s62, s62, 225
    s_cmp_lt_i32 s12, 0
    s_cbranch_scc1 L_Ks0
    s_branch L_Kt01
L_Ks0:
    s_waitcnt vmcnt(4)
    v_dot2_f32_bf16 v16, v60, v8, 0
    v_dot2_f32_bf16 v16, v61, v9, v16
    v_dot2_f32_bf16 v16, v62, v10, v16
    v_dot2_f32_bf16 v16, v63, v11, v16
    buffer_load_dwordx4 v[80:83], v5, s[44:47], s53 offen offset:1024 nt
    s_waitcnt vmcnt(4)
    v_dot2_f32_bf16 v17, v64, v8, 0
    v_dot2_f32_bf16 v17, v65, v9, v17
    v_dot2_f32_bf16 v17, v66, v10, v17
    v_dot2_f32_bf16 v17, v67, v11, v17
    buffer_load_dwordx4 v[84:87], v5, s[44:47], s53 offen offset:2048 nt
    s_waitcnt vmcnt(4)
    v_dot2_f32_bf16 v18, v68, v8, 0
    v_dot2_f32_bf16 v18, v69, v9, v18
    v_dot2_f32_bf16 v18, v70, v10, v18
    v_dot2_f32_bf16 v18, v71, v11, v18
    buffer_load_dwordx4 v[88:91], v5, s[44:47], s53 offen offset:3072 nt
    s_waitcnt vmcnt(4)
    v_dot2_f32_bf16 v19, v72, v8, 0
    v_dot2_f32_bf16 v19, v73, v9, v19
    v_dot2_f32_bf16 v19, v74, v10, v19
    v_dot2_f32_bf16 v19, v75, v11, v19
    buffer_load_dwordx4 v[92:95], v5, s[44:47], s54 offen offset:0 nt
    v_add_f32_dpp v16, v16, v16 row_ror:8 row_mask:0xf bank_mask:0x3
    v_add_f32_dpp v16, v17, v17 row_ror:8 row_mask:0xf bank_mask:0xc
    s_waitcnt vmcnt(4)
    v_dot2_f32_bf16 v20, v76, v8, 0
    v_dot2_f32_bf16 v20, v77, v9, v20
    v_dot2_f32_bf16 v20, v78, v10, v20
    v_dot2_f32_bf16 v20, v79, v11, v20
    buffer_load_dwordx4 v[96:99], v5, s[44:47], s54 offen offset:1024 nt
    s_waitcnt vmcnt(4)
    v_dot2_f32_bf16 v21, v80, v8, 0
    v_dot2_f32_bf16 v21, v81, v9, v21
    v_dot2_f32_bf16 v21, v82, v10, v21
    v_dot2_f32_bf16 v21, v83, v11, v21
    buffer_load_dwordx4 v[100:103], v5, s[44:47], s54 offen offset:2048 nt
    v_add_f32_dpp v18, v18, v18 row_ror:8 row_mask:0xf bank_mask:0x3
    v_add_f32_dpp v18, v19, v19 row_ror:8 row_mask:0xf bank_mask:0xc
    s_waitcnt vmcnt(4)
    v_dot2_f32_bf16 v22, v84, v8, 0
    v_dot2_f32_bf16 v22, v85, v9, v22
    v_dot2_f32_bf16 v22, v86, v10, v22
    v_dot2_f32_bf16 v22, v87, v11, v22
    buffer_load_dwordx4 v[104:107], v5, s[44:47], s54 offen offset:3072 nt
    s_waitcnt vmcnt(4)
    v_dot2_f32_bf16 v23, v88, v8, 0
    v_dot2_f32_bf16 v23, v89, v9, v23
    v_dot2_f32_bf16 v23, v90, v10, v23
    v_dot2_f32_bf16 v23, v91, v11, v23
    buffer_load_dwordx4 v[108:111], v5, s[44:47], s55 offen offset:0 nt
    v_add_f32_dpp v20, v20, v20 row_ror:8 row_mask:0xf bank_mask:0x3
    v_add_f32_dpp v20, v21, v21 row_ror:8 row_mask:0xf bank_mask:0xc
    v_add_f32_dpp v16, v16, v16 row_ror:12 row_mask:0xf bank_mask:0x5
    v_add_f32_dpp v16, v18, v18 row_ror:4 row_mask:0xf bank_mask:0xa
    v_add_f32_dpp v22, v22, v22 row_ror:8 row_mask:0xf bank_mask:0x3
    v_add_f32_dpp v22, v23, v23 row_ror:8 row_mask:0xf bank_mask:0xc
    v_add_f32_dpp v20, v20, v20 row_ror:12 row_mask:0xf bank_mask:0x5
    v_add_f32_dpp v16, v16, v16 quad_perm:[1,0,3,2] row_mask:0xf bank_mask:0xf
    v_add_f32_dpp v20, v22, v22 row_ror:4 row_mask:0xf bank_mask:0xa
    s_nop 0
    v_add_f32_dpp v16, v16, v16 quad_perm:[2,3,0,1] row_mask:0xf bank_mask:0xf
    v_add_f32_dpp v20, v20, v20 quad_perm:[1,0,3,2] row_mask:0xf bank_mask:0xf
    s_nop 1
    v_add_f32_dpp v20, v20, v20 quad_perm:[2,3,0,1] row_mask:0xf bank_mask:0xf
    v_cvt_pk_bf16_f32 v44, v16, v20
    v_lshlrev_b32 v12, 16, v44
    v_and_b32 v13, s8, v44
    v_mul_f32 v12, s13, v12
    v_mul_f32 v13, s13, v13
    v_cvt_pk_bf16_f32 v44, v12, v13
    v_lshlrev_b32 v12, 16, v44
    v_and_b32 v13, s8, v44
    v_max3_f32 v40, v12, v13, v40
    s_memrealtime s[80:81]
    s_waitcnt vmcnt(4)
    v_dot2_f32_bf16 v16, v92, v8, 0
    v_dot2_f32_bf16 v16, v93, v9, v16
    v_dot2_f32_bf16 v16, v94, v10, v16
    v_dot2_f32_bf16 v16, v95, v11, v16
    buffer_load_dwordx4 v[112:115], v5, s[44:47], s55 offen offset:1024 nt
    s_waitcnt vmcnt(4)
    v_dot2_f32_bf16 v17, v96, v8, 0
    v_dot2_f32_bf16 v17, v97, v9, v17
    v_dot2_f32_bf16 v17, v98, v10, v17
    v_dot2_f32_bf16 v17, v99, v11, v17
    buffer_load_dwordx4 v[116:119], v5, s[44:47], s55 offen offset:2048 nt
    s_waitcnt vmcnt(4)
    v_dot2_f32_bf16 v18, v100, v8, 0
    v_dot2_f32_bf16 v18, v101, v9, v18
    v_dot2_f32_bf16 v18, v102, v10, v18
    v_dot2_f32_bf16 v18, v103, v11, v18
    buffer_load_dwordx4 v[120:123], v5, s[44:47], s55 offen offset:3072 nt
    s_waitcnt vmcnt(4)
    v_dot2_f32_bf16 v19, v104, v8, 0
    v_dot2_f32_bf16 v19, v105, v9, v19
    v_dot2_f32_bf16 v19, v106, v10, v19
    v_dot2_f32_bf16 v19, v107, v11, v19
    buffer_load_dwordx4 v[60:63], v5, s[68:71], s56 offen offset:0 nt
    v_add_f32_dpp v16, v16, v16 row_ror:8 row_mask:0xf bank_mask:0x3
    v_add_f32_dpp v16, v17, v17 row_ror:8 row_mask:0xf bank_mask:0xc
    s_waitcnt vmcnt(4)
    v_dot2_f32_bf16 v20, v108, v8, 0
    v_dot2_f32_bf16 v20, v109, v9, v20
    v_dot2_f32_bf16 v20, v110, v10, v20
    v_dot2_f32_bf16 v20, v111, v11, v20
    buffer_load_dwordx4 v[64:67], v5, s[68:71], s56 offen offset:1024 nt
    s_waitcnt vmcnt(4)
    v_dot2_f32_bf16 v21, v112, v8, 0
    v_dot2_f32_bf16 v21, v113, v9, v21
    v_dot2_f32_bf16 v21, v114, v10, v21
    v_dot2_f32_bf16 v21, v115, v11, v21
    buffer_load_dwordx4 v[68:71], v5, s[68:71], s56 offen offset:2048 nt
    v_add_f32_dpp v18, v18, v18 row_ror:8 row_mask:0xf bank_mask:0x3
    v_add_f32_dpp v18, v19, v19 row_ror:8 row_mask:0xf bank_mask:0xc
    s_waitcnt vmcnt(4)
    v_dot2_f32_bf16 v22, v116, v8, 0
    v_dot2_f32_bf16 v22, v117, v9, v22
    v_dot2_f32_bf16 v22, v118, v10, v22
    v_dot2_f32_bf16 v22, v119, v11, v22
    buffer_load_dwordx4 v[72:75], v5, s[68:71], s56 offen offset:3072 nt
    s_waitcnt vmcnt(4)
    v_dot2_f32_bf16 v23, v120, v8, 0
    v_dot2_f32_bf16 v23, v121, v9, v23
    v_dot2_f32_bf16 v23, v122, v10, v23
    v_dot2_f32_bf16 v23, v123, v11, v23
    buffer_load_dwordx4 v[76:79], v5, s[68:71], s57 offen offset:0 nt
    v_add_f32_dpp v20, v20, v20 row_ror:8 row_mask:0xf bank_mask:0x3
    v_add_f32_dpp v20, v21, v21 row_ror:8 row_mask:0xf bank_mask:0xc
    v_add_f32_dpp v16, v16, v16 row_ror:12 row_mask:0xf bank_mask:0x5
    v_add_f32_dpp v16, v18, v18 row_ror:4 row_mask:0xf bank_mask:0xa
    v_add_f32_dpp v22, v22, v22 row_ror:8 row_mask:0xf bank_mask:0x3
    v_add_f32_dpp v22, v23, v23 row_ror:8 row_mask:0xf bank_mask:0xc
    v_add_f32_dpp v20, v20, v20 row_ror:12 row_mask:0xf bank_mask:0x5
    v_add_f32_dpp v16, v16, v16 quad_perm:[1,0,3,2] row_mask:0xf bank_mask:0xf
    v_add_f32_dpp v20, v22, v22 row_ror:4 row_mask:0xf bank_mask:0xa
    s_nop 0
    v_add_f32_dpp v16, v16, v16 quad_perm:[2,3,0,1] row_mask:0xf bank_mask:0xf
    v_add_f32_dpp v20, v20, v20 quad_perm:[1,0,3,2] row_mask:0xf bank_mask:0xf
    s_nop 1
    v_add_f32_dpp v20, v20, v20 quad_perm:[2,3,0,1] row_mask:0xf bank_mask:0xf
    v_cvt_pk_bf16_f32 v44, v16, v20
    v_lshlrev_b32 v14, 16, v44
    v_and_b32 v15, s8, v44
    v_mul_f32 v14, s13, v14
    v_mul_f32 v15, s13, v15
    v_cvt_pk_bf16_f32 v44, v14, v15
    v_lshlrev_b32 v14, 16, v44
    v_and_b32 v15, s8, v44
    v_max3_f32 v40, v14, v15, v40
    ds_write_b128 v43, v[12:15]
    v_add_u32 v43, 0x100, v43
    s_mov_b32 s52, s56
    s_mov_b32 s53, s57
    s_mov_b32 s54, s58
    s_mov_b32 s55, s59
    s_add_u32 s56, s56, 0x10000
    s_add_u32 s57, s57, 0x10000
    s_add_u32 s58, s58, 0x10000
    s_add_u32 s59, s59, 0x10000
    s_add_u32 s15, s15, 1
    s_waitcnt lgkmcnt(0)
    s_cmp_ge_u32 s15, 15
    s_cbranch_scc1 L_kv0
    s_sub_u32 s12, s80, s62
    s_add_u32 s62, s62, 225
    s_cmp_lt_i32 s12, 0
    s_cbranch_scc1 L_Ks0
    s_branch L_Kt01
L_Vt01:
    buffer_load_dwordx4 v[80:83], v5, s[48:51], s53 offen offset:1024 nt
    buffer_load_dwordx4 v[84:87], v5, s[48:51], s53 offen offset:2048 nt
    buffer_load_dwordx4 v[88:91], v5, s[48:51], s53 offen offset:3072 nt
    buffer_load_dwordx4 v[92:95], v5, s[48:51], s54 offen offset:0 nt
    buffer_load_dwordx4 v[96:99], v5, s[48:51], s54 offen offset:1024 nt
L_Vs1:
    ds_read_b128 v[12:15], v43
    v_add_u32 v43, 0x100, v43
    s_waitcnt lgkmcnt(0)
    v_sub_f32 v12, v12, v40
    v_sub_f32 v13, v13, v40
    v_sub_f32 v14, v14, v40
    v_sub_f32 v15, v15, v40
    v_mul_f32 v12, s14, v12
    v_mul_f32 v13, s14, v13
    v_mul_f32 v14, s14, v14
    v_mul_f32 v15, s14, v15
    v_exp_f32 v12, v12
    v_exp_f32 v13, v13
    v_exp_f32 v14, v14
    v_exp_f32 v15, v15
    s_nop 0
    v_mov_b32_dpp v16, v12 row_newbcast:0 row_mask:0xf bank_mask:0xf
    v_mov_b32_dpp v17, v12 row_newbcast:8 row_mask:0xf bank_mask:0xf
    v_mov_b32_dpp v18, v12 row_newbcast:4 row_mask:0xf bank_mask:0xf
    v_mov_b32_dpp v19, v12 row_newbcast:12 row_mask:0xf bank_mask:0xf
    v_mov_b32_dpp v20, v13 row_newbcast:0 row_mask:0xf bank_mask:0xf
    v_mov_b32_dpp v21, v13 row_newbcast:8 row_mask:0xf bank_mask:0xf
    v_mov_b32_dpp v22, v13 row_newbcast:4 row_mask:0xf bank_mask:0xf
    v_mov_b32_dpp v23, v13 row_newbcast:12 row_mask:0xf bank_mask:0xf
    v_mov_b32_dpp v24, v14 row_newbcast:0 row_mask:0xf bank_mask:0xf
    v_mov_b32_dpp v25, v14 row_newbcast:8 row_mask:0xf bank_mask:0xf
    v_mov_b32_dpp v26, v14 row_newbcast:4 row_mask:0xf bank_mask:0xf
    v_mov_b32_dpp v27, v14 row_newbcast:12 row_mask:0xf bank_mask:0xf
    v_mov_b32_dpp v28, v15 row_newbcast:0 row_mask:0xf bank_mask:0xf
    v_mov_b32_dpp v29, v15 row_newbcast:8 row_mask:0xf bank_mask:0xf
    v_mov_b32_dpp v30, v15 row_newbcast:4 row_mask:0xf bank_mask:0xf
    v_mov_b32_dpp v31, v15 row_newbcast:12 row_mask:0xf bank_mask:0xf
    v_add_f32 v12, v12, v13
    v_add_f32 v14, v14, v15
    v_add_f32 v41, v41, v12
    v_add_f32 v41, v41, v14
    s_waitcnt vmcnt(9)
    v_lshlrev_b32 v44, 16, v60
    v_and_b32 v45, s8, v60
    v_lshlrev_b32 v46, 16, v61
    v_and_b32 v47, s8, v61
    v_lshlrev_b32 v48, 16, v62
    v_and_b32 v49, s8, v62
    v_lshlrev_b32 v50, 16, v63
    v_and_b32 v51, s8, v63
    buffer_load_dwordx4 v[100:103], v5, s[48:51], s54 offen offset:2048 nt
    v_pk_fma_f32 v[32:33], v[44:45], v[16:17], v[32:33] op_sel_hi:[1,0,1]
    v_pk_fma_f32 v[34:35], v[46:47], v[16:17], v[34:35] op_sel_hi:[1,0,1]
    v_pk_fma_f32 v[36:37], v[48:49], v[16:17], v[36:37] op_sel_hi:[1,0,1]
    v_pk_fma_f32 v[38:39], v[50:51], v[16:17], v[38:39] op_sel_hi:[1,0,1]
    s_waitcnt vmcnt(9)
    v_lshlrev_b32 v52, 16, v64
    v_and_b32 v53, s8, v64
    v_lshlrev_b32 v54, 16, v65
    v_and_b32 v55, s8, v65
    v_lshlrev_b32 v56, 16, v66
    v_and_b32 v57, s8, v66
    v_lshlrev_b32 v58, 16, v67
    v_and_b32 v59, s8, v67
    buffer_load_dwordx4 v[104:107], v5, s[48:51], s54 offen offset:3072 nt
    v_pk_fma_f32 v[32:33], v[52:53], v[16:17], v[32:33] op_sel:[0,1,0] op_sel_hi:[1,1,1]
    v_pk_fma_f32 v[34:35], v[54:55], v[16:17], v[34:35] op_sel:[0,1,0] op_sel_hi:[1,1,1]
    v_pk_fma_f32 v[36:37], v[56:57], v[16:17], v[36:37] op_sel:[0,1,0] op_sel_hi:[1,1,1]
    v_pk_fma_f32 v[38:39], v[58:59], v[16:17], v[38:39] op_sel:[0,1,0] op_sel_hi:[1,1,1]
    s_waitcnt vmcnt(9)
    v_lshlrev_b32 v44, 16, v68
    v_and_b32 v45, s8, v68
    v_lshlrev_b32 v46, 16, v69
    v_and_b32 v47, s8, v69
    v_lshlrev_b32 v48, 16, v70
    v_and_b32 v49, s8, v70
    v_lshlrev_b32 v50, 16, v71
    v_and_b32 v51, s8, v71
    buffer_load_dwordx4 v[108:111], v5, s[48:51], s55 offen offset:0 nt
    v_pk_fma_f32 v[32:33], v[44:45], v[18:19], v[32:33] op_sel_hi:[1,0,1]
    v_pk_fma_f32 v[34:35], v[46:47], v[18:19], v[34:35] op_sel_hi:[1,0,1]
    v_pk_fma_f32 v[36:37], v[48:49], v[18:19], v[36:37] op_sel_hi:[1,0,1]
    v_pk_fma_f32 v[38:39], v[50:51], v[18:19], v[38:39] op_sel_hi:[1,0,1]
    s_waitcnt vmcnt(9)
    v_lshlrev_b32 v52, 16, v72
    v_and_b32 v53, s8, v72
    v_lshlrev_b32 v54, 16, v73
    v_and_b32 v55, s8, v73
    v_lshlrev_b32 v56, 16, v74
    v_and_b32 v57, s8, v74
    v_lshlrev_b32 v58, 16, v75
    v_and_b32 v59, s8, v75
    buffer_load_dwordx4 v[112:115], v5, s[48:51], s55 offen offset:1024 nt
    v_pk_fma_f32 v[32:33], v[52:53], v[18:19], v[32:33] op_sel:[0,1,0] op_sel_hi:[1,1,1]
    v_pk_fma_f32 v[34:35], v[54:55], v[18:19], v[34:35] op_sel:[0,1,0] op_sel_hi:[1,1,1]
    v_pk_fma_f32 v[36:37], v[56:57], v[18:19], v[36:37] op_sel:[0,1,0] op_sel_hi:[1,1,1]
    v_pk_fma_f32 v[38:39], v[58:59], v[18:19], v[38:39] op_sel:[0,1,0] op_sel_hi:[1,1,1]
    s_waitcnt vmcnt(9)
    v_lshlrev_b32 v44, 16, v76
    v_and_b32 v45, s8, v76
    v_lshlrev_b32 v46, 16, v77
    v_and_b32 v47, s8, v77
    v_lshlrev_b32 v48, 16, v78
    v_and_b32 v49, s8, v78
    v_lshlrev_b32 v50, 16, v79
    v_and_b32 v51, s8, v79
    buffer_load_dwordx4 v[116:119], v5, s[48:51], s55 offen offset:2048 nt
    v_pk_fma_f32 v[32:33], v[44:45], v[20:21], v[32:33] op_sel_hi:[1,0,1]
    v_pk_fma_f32 v[34:35], v[46:47], v[20:21], v[34:35] op_sel_hi:[1,0,1]
    v_pk_fma_f32 v[36:37], v[48:49], v[20:21], v[36:37] op_sel_hi:[1,0,1]
    v_pk_fma_f32 v[38:39], v[50:51], v[20:21], v[38:39] op_sel_hi:[1,0,1]
    s_waitcnt vmcnt(9)
    v_lshlrev_b32 v52, 16, v80
    v_and_b32 v53, s8, v80
    v_lshlrev_b32 v54, 16, v81
    v_and_b32 v55, s8, v81
    v_lshlrev_b32 v56, 16, v82
    v_and_b32 v57, s8, v82
    v_lshlrev_b32 v58, 16, v83
    v_and_b32 v59, s8, v83
    buffer_load_dwordx4 v[120:123], v5, s[48:51], s55 offen offset:3072 nt
    v_pk_fma_f32 v[32:33], v[52:53], v[20:21], v[32:33] op_sel:[0,1,0] op_sel_hi:[1,1,1]
    v_pk_fma_f32 v[34:35], v[54:55], v[20:21], v[34:35] op_sel:[0,1,0] op_sel_hi:[1,1,1]
    v_pk_fma_f32 v[36:37], v[56:57], v[20:21], v[36:37] op_sel:[0,1,0] op_sel_hi:[1,1,1]
    v_pk_fma_f32 v[38:39], v[58:59], v[20:21], v[38:39] op_sel:[0,1,0] op_sel_hi:[1,1,1]
    s_waitcnt vmcnt(9)
    v_lshlrev_b32 v44, 16, v84
    v_and_b32 v45, s8, v84
    v_lshlrev_b32 v46, 16, v85
    v_and_b32 v47, s8, v85
    v_lshlrev_b32 v48, 16, v86
    v_and_b32 v49, s8, v86
    v_lshlrev_b32 v50, 16, v87
    v_and_b32 v51, s8, v87
    buffer_load_dwordx4 v[60:63], v5, s[48:51], s56 offen offset:0 nt
    v_pk_fma_f32 v[32:33], v[44:45], v[22:23], v[32:33] op_sel_hi:[1,0,1]
    v_pk_fma_f32 v[34:35], v[46:47], v[22:23], v[34:35] op_sel_hi:[1,0,1]
    v_pk_fma_f32 v[36:37], v[48:49], v[22:23], v[36:37] op_sel_hi:[1,0,1]
    v_pk_fma_f32 v[38:39], v[50:51], v[22:23], v[38:39] op_sel_hi:[1,0,1]
    s_waitcnt vmcnt(9)
    v_lshlrev_b32 v52, 16, v88
    v_and_b32 v53, s8, v88
    v_lshlrev_b32 v54, 16, v89
    v_and_b32 v55, s8, v89
    v_lshlrev_b32 v56, 16, v90
    v_and_b32 v57, s8, v90
    v_lshlrev_b32 v58, 16, v91
    v_and_b32 v59, s8, v91
    buffer_load_dwordx4 v[64:67], v5, s[48:51], s56 offen offset:1024 nt
    v_pk_fma_f32 v[32:33], v[52:53], v[22:23], v[32:33] op_sel:[0,1,0] op_sel_hi:[1,1,1]
    v_pk_fma_f32 v[34:35], v[54:55], v[22:23], v[34:35] op_sel:[0,1,0] op_sel_hi:[1,1,1]
    v_pk_fma_f32 v[36:37], v[56:57], v[22:23], v[36:37] op_sel:[0,1,0] op_sel_hi:[1,1,1]
    v_pk_fma_f32 v[38:39], v[58:59], v[22:23], v[38:39] op_sel:[0,1,0] op_sel_hi:[1,1,1]
    s_memrealtime s[80:81]
    s_waitcnt vmcnt(9)
    v_lshlrev_b32 v44, 16, v92
    v_and_b32 v45, s8, v92
    v_lshlrev_b32 v46, 16, v93
    v_and_b32 v47, s8, v93
    v_lshlrev_b32 v48, 16, v94
    v_and_b32 v49, s8, v94
    v_lshlrev_b32 v50, 16, v95
    v_and_b32 v51, s8, v95
    buffer_load_dwordx4 v[68:71], v5, s[48:51], s56 offen offset:2048 nt
    v_pk_fma_f32 v[32:33], v[44:45], v[24:25], v[32:33] op_sel_hi:[1,0,1]
    v_pk_fma_f32 v[34:35], v[46:47], v[24:25], v[34:35] op_sel_hi:[1,0,1]
    v_pk_fma_f32 v[36:37], v[48:49], v[24:25], v[36:37] op_sel_hi:[1,0,1]
    v_pk_fma_f32 v[38:39], v[50:51], v[24:25], v[38:39] op_sel_hi:[1,0,1]
    s_waitcnt vmcnt(9)
    v_lshlrev_b32 v52, 16, v96
    v_and_b32 v53, s8, v96
    v_lshlrev_b32 v54, 16, v97
    v_and_b32 v55, s8, v97
    v_lshlrev_b32 v56, 16, v98
    v_and_b32 v57, s8, v98
    v_lshlrev_b32 v58, 16, v99
    v_and_b32 v59, s8, v99
    buffer_load_dwordx4 v[72:75], v5, s[48:51], s56 offen offset:3072 nt
    v_pk_fma_f32 v[32:33], v[52:53], v[24:25], v[32:33] op_sel:[0,1,0] op_sel_hi:[1,1,1]
    v_pk_fma_f32 v[34:35], v[54:55], v[24:25], v[34:35] op_sel:[0,1,0] op_sel_hi:[1,1,1]
    v_pk_fma_f32 v[36:37], v[56:57], v[24:25], v[36:37] op_sel:[0,1,0] op_sel_hi:[1,1,1]
    v_pk_fma_f32 v[38:39], v[58:59], v[24:25], v[38:39] op_sel:[0,1,0] op_sel_hi:[1,1,1]
    s_waitcnt vmcnt(9)
    v_lshlrev_b32 v44, 16, v100
    v_and_b32 v45, s8, v100
    v_lshlrev_b32 v46, 16, v101
    v_and_b32 v47, s8, v101
    v_lshlrev_b32 v48, 16, v102
    v_and_b32 v49, s8, v102
    v_lshlrev_b32 v50, 16, v103
    v_and_b32 v51, s8, v103
    buffer_load_dwordx4 v[76:79], v5, s[48:51], s57 offen offset:0 nt
    v_pk_fma_f32 v[32:33], v[44:45], v[26:27], v[32:33] op_sel_hi:[1,0,1]
    v_pk_fma_f32 v[34:35], v[46:47], v[26:27], v[34:35] op_sel_hi:[1,0,1]
    v_pk_fma_f32 v[36:37], v[48:49], v[26:27], v[36:37] op_sel_hi:[1,0,1]
    v_pk_fma_f32 v[38:39], v[50:51], v[26:27], v[38:39] op_sel_hi:[1,0,1]
    s_waitcnt vmcnt(9)
    v_lshlrev_b32 v52, 16, v104
    v_and_b32 v53, s8, v104
    v_lshlrev_b32 v54, 16, v105
    v_and_b32 v55, s8, v105
    v_lshlrev_b32 v56, 16, v106
    v_and_b32 v57, s8, v106
    v_lshlrev_b32 v58, 16, v107
    v_and_b32 v59, s8, v107
    buffer_load_dwordx4 v[80:83], v5, s[48:51], s57 offen offset:1024 nt
    v_pk_fma_f32 v[32:33], v[52:53], v[26:27], v[32:33] op_sel:[0,1,0] op_sel_hi:[1,1,1]
    v_pk_fma_f32 v[34:35], v[54:55], v[26:27], v[34:35] op_sel:[0,1,0] op_sel_hi:[1,1,1]
    v_pk_fma_f32 v[36:37], v[56:57], v[26:27], v[36:37] op_sel:[0,1,0] op_sel_hi:[1,1,1]
    v_pk_fma_f32 v[38:39], v[58:59], v[26:27], v[38:39] op_sel:[0,1,0] op_sel_hi:[1,1,1]
    s_waitcnt vmcnt(9)
    v_lshlrev_b32 v44, 16, v108
    v_and_b32 v45, s8, v108
    v_lshlrev_b32 v46, 16, v109
    v_and_b32 v47, s8, v109
    v_lshlrev_b32 v48, 16, v110
    v_and_b32 v49, s8, v110
    v_lshlrev_b32 v50, 16, v111
    v_and_b32 v51, s8, v111
    buffer_load_dwordx4 v[84:87], v5, s[48:51], s57 offen offset:2048 nt
    v_pk_fma_f32 v[32:33], v[44:45], v[28:29], v[32:33] op_sel_hi:[1,0,1]
    v_pk_fma_f32 v[34:35], v[46:47], v[28:29], v[34:35] op_sel_hi:[1,0,1]
    v_pk_fma_f32 v[36:37], v[48:49], v[28:29], v[36:37] op_sel_hi:[1,0,1]
    v_pk_fma_f32 v[38:39], v[50:51], v[28:29], v[38:39] op_sel_hi:[1,0,1]
    s_waitcnt vmcnt(9)
    v_lshlrev_b32 v52, 16, v112
    v_and_b32 v53, s8, v112
    v_lshlrev_b32 v54, 16, v113
    v_and_b32 v55, s8, v113
    v_lshlrev_b32 v56, 16, v114
    v_and_b32 v57, s8, v114
    v_lshlrev_b32 v58, 16, v115
    v_and_b32 v59, s8, v115
    buffer_load_dwordx4 v[88:91], v5, s[48:51], s57 offen offset:3072 nt
    v_pk_fma_f32 v[32:33], v[52:53], v[28:29], v[32:33] op_sel:[0,1,0] op_sel_hi:[1,1,1]
    v_pk_fma_f32 v[34:35], v[54:55], v[28:29], v[34:35] op_sel:[0,1,0] op_sel_hi:[1,1,1]
    v_pk_fma_f32 v[36:37], v[56:57], v[28:29], v[36:37] op_sel:[0,1,0] op_sel_hi:[1,1,1]
    v_pk_fma_f32 v[38:39], v[58:59], v[28:29], v[38:39] op_sel:[0,1,0] op_sel_hi:[1,1,1]
    s_waitcnt vmcnt(9)
    v_lshlrev_b32 v44, 16, v116
    v_and_b32 v45, s8, v116
    v_lshlrev_b32 v46, 16, v117
    v_and_b32 v47, s8, v117
    v_lshlrev_b32 v48, 16, v118
    v_and_b32 v49, s8, v118
    v_lshlrev_b32 v50, 16, v119
    v_and_b32 v51, s8, v119
    buffer_load_dwordx4 v[92:95], v5, s[48:51], s58 offen offset:0 nt
    v_pk_fma_f32 v[32:33], v[44:45], v[30:31], v[32:33] op_sel_hi:[1,0,1]
    v_pk_fma_f32 v[34:35], v[46:47], v[30:31], v[34:35] op_sel_hi:[1,0,1]
    v_pk_fma_f32 v[36:37], v[48:49], v[30:31], v[36:37] op_sel_hi:[1,0,1]
    v_pk_fma_f32 v[38:39], v[50:51], v[30:31], v[38:39] op_sel_hi:[1,0,1]
    s_waitcnt vmcnt(9)
    v_lshlrev_b32 v52, 16, v120
    v_and_b32 v53, s8, v120
    v_lshlrev_b32 v54, 16, v121
    v_and_b32 v55, s8, v121
    v_lshlrev_b32 v56, 16, v122
    v_and_b32 v57, s8, v122
    v_lshlrev_b32 v58, 16, v123
    v_and_b32 v59, s8, v123
    buffer_load_dwordx4 v[96:99], v5, s[48:51], s58 offen offset:1024 nt
    v_pk_fma_f32 v[32:33], v[52:53], v[30:31], v[32:33] op_sel:[0,1,0] op_sel_hi:[1,1,1]
    v_pk_fma_f32 v[34:35], v[54:55], v[30:31], v[34:35] op_sel:[0,1,0] op_sel_hi:[1,1,1]
    v_pk_fma_f32 v[36:37], v[56:57], v[30:31], v[36:37] op_sel:[0,1,0] op_sel_hi:[1,1,1]
    v_pk_fma_f32 v[38:39], v[58:59], v[30:31], v[38:39] op_sel:[0,1,0] op_sel_hi:[1,1,1]
    s_mov_b32 s52, s56
    s_mov_b32 s53, s57
    s_mov_b32 s54, s58
    s_mov_b32 s55, s59
    s_add_u32 s56, s56, 0x10000
    s_add_u32 s57, s57, 0x10000
    s_add_u32 s58, s58, 0x10000
    s_add_u32 s59, s59, 0x10000
    s_add_u32 s15, s15, 1
    s_waitcnt lgkmcnt(0)
    s_cmp_ge_u32 s15, 32
    s_cbranch_scc1 L_sdone
    s_sub_u32 s12, s80, s62
    s_add_u32 s62, s62, 225
    s_cmp_lt_i32 s12, 0
    s_cbranch_scc1 L_Vt10
    s_branch L_Vs1
L_Vt10:
    ds_read_b128 v[12:15], v43
    v_add_u32 v43, 0x100, v43
    s_waitcnt lgkmcnt(0)
    v_sub_f32 v12, v12, v40
    v_sub_f32 v13, v13, v40
    v_sub_f32 v14, v14, v40
    v_sub_f32 v15, v15, v40
    v_mul_f32 v12, s14, v12
    v_mul_f32 v13, s14, v13
    v_mul_f32 v14, s14, v14
    v_mul_f32 v15, s14, v15
    v_exp_f32 v12, v12
    v_exp_f32 v13, v13
    v_exp_f32 v14, v14
    v_exp_f32 v15, v15
    s_nop 0
    v_mov_b32_dpp v16, v12 row_newbcast:0 row_mask:0xf bank_mask:0xf
    v_mov_b32_dpp v17, v12 row_newbcast:8 row_mask:0xf bank_mask:0xf
    v_mov_b32_dpp v18, v12 row_newbcast:4 row_mask:0xf bank_mask:0xf
    v_mov_b32_dpp v19, v12 row_newbcast:12 row_mask:0xf bank_mask:0xf
    v_mov_b32_dpp v20, v13 row_newbcast:0 row_mask:0xf bank_mask:0xf
    v_mov_b32_dpp v21, v13 row_newbcast:8 row_mask:0xf bank_mask:0xf
    v_mov_b32_dpp v22, v13 row_newbcast:4 row_mask:0xf bank_mask:0xf
    v_mov_b32_dpp v23, v13 row_newbcast:12 row_mask:0xf bank_mask:0xf
    v_mov_b32_dpp v24, v14 row_newbcast:0 row_mask:0xf bank_mask:0xf
    v_mov_b32_dpp v25, v14 row_newbcast:8 row_mask:0xf bank_mask:0xf
    v_mov_b32_dpp v26, v14 row_newbcast:4 row_mask:0xf bank_mask:0xf
    v_mov_b32_dpp v27, v14 row_newbcast:12 row_mask:0xf bank_mask:0xf
    v_mov_b32_dpp v28, v15 row_newbcast:0 row_mask:0xf bank_mask:0xf
    v_mov_b32_dpp v29, v15 row_newbcast:8 row_mask:0xf bank_mask:0xf
    v_mov_b32_dpp v30, v15 row_newbcast:4 row_mask:0xf bank_mask:0xf
    v_mov_b32_dpp v31, v15 row_newbcast:12 row_mask:0xf bank_mask:0xf
    v_add_f32 v12, v12, v13
    v_add_f32 v14, v14, v15
    v_add_f32 v41, v41, v12
    v_add_f32 v41, v41, v14
    s_waitcnt vmcnt(9)
    v_lshlrev_b32 v44, 16, v60
    v_and_b32 v45, s8, v60
    v_lshlrev_b32 v46, 16, v61
    v_and_b32 v47, s8, v61
    v_lshlrev_b32 v48, 16, v62
    v_and_b32 v49, s8, v62
    v_lshlrev_b32 v50, 16, v63
    v_and_b32 v51, s8, v63
    v_pk_fma_f32 v[32:33], v[44:45], v[16:17], v[32:33] op_sel_hi:[1,0,1]
    v_pk_fma_f32 v[34:35], v[46:47], v[16:17], v[34:35] op_sel_hi:[1,0,1]
    v_pk_fma_f32 v[36:37], v[48:49], v[16:17], v[36:37] op_sel_hi:[1,0,1]
    v_pk_fma_f32 v[38:39], v[50:51], v[16:17], v[38:39] op_sel_hi:[1,0,1]
    s_waitcnt vmcnt(8)
    v_lshlrev_b32 v52, 16, v64
    v_and_b32 v53, s8, v64
    v_lshlrev_b32 v54, 16, v65
    v_and_b32 v55, s8, v65
    v_lshlrev_b32 v56, 16, v66
    v_and_b32 v57, s8, v66
    v_lshlrev_b32 v58, 16, v67
    v_and_b32 v59, s8, v67
    v_pk_fma_f32 v[32:33], v[52:53], v[16:17], v[32:33] op_sel:[0,1,0] op_sel_hi:[1,1,1]
    v_pk_fma_f32 v[34:35], v[54:55], v[16:17], v[34:35] op_sel:[0,1,0] op_sel_hi:[1,1,1]
    v_pk_fma_f32 v[36:37], v[56:57], v[16:17], v[36:37] op_sel:[0,1,0] op_sel_hi:[1,1,1]
    v_pk_fma_f32 v[38:39], v[58:59], v[16:17], v[38:39] op_sel:[0,1,0] op_sel_hi:[1,1,1]
    s_waitcnt vmcnt(7)
    v_lshlrev_b32 v44, 16, v68
    v_and_b32 v45, s8, v68
    v_lshlrev_b32 v46, 16, v69
    v_and_b32 v47, s8, v69
    v_lshlrev_b32 v48, 16, v70
    v_and_b32 v49, s8, v70
    v_lshlrev_b32 v50, 16, v71
    v_and_b32 v51, s8, v71
    v_pk_fma_f32 v[32:33], v[44:45], v[18:19], v[32:33] op_sel_hi:[1,0,1]
    v_pk_fma_f32 v[34:35], v[46:47], v[18:19], v[34:35] op_sel_hi:[1,0,1]
    v_pk_fma_f32 v[36:37], v[48:49], v[18:19], v[36:37] op_sel_hi:[1,0,1]
    v_pk_fma_f32 v[38:39], v[50:51], v[18:19], v[38:39] op_sel_hi:[1,0,1]
    s_waitcnt vmcnt(6)
    v_lshlrev_b32 v52, 16, v72
    v_and_b32 v53, s8, v72
    v_lshlrev_b32 v54, 16, v73
    v_and_b32 v55, s8, v73
    v_lshlrev_b32 v56, 16, v74
    v_and_b32 v57, s8, v74
    v_lshlrev_b32 v58, 16, v75
    v_and_b32 v59, s8, v75
    v_pk_fma_f32 v[32:33], v[52:53], v[18:19], v[32:33] op_sel:[0,1,0] op_sel_hi:[1,1,1]
    v_pk_fma_f32 v[34:35], v[54:55], v[18:19], v[34:35] op_sel:[0,1,0] op_sel_hi:[1,1,1]
    v_pk_fma_f32 v[36:37], v[56:57], v[18:19], v[36:37] op_sel:[0,1,0] op_sel_hi:[1,1,1]
    v_pk_fma_f32 v[38:39], v[58:59], v[18:19], v[38:39] op_sel:[0,1,0] op_sel_hi:[1,1,1]
    s_waitcnt vmcnt(5)
    v_lshlrev_b32 v44, 16, v76
    v_and_b32 v45, s8, v76
    v_lshlrev_b32 v46, 16, v77
    v_and_b32 v47, s8, v77
    v_lshlrev_b32 v48, 16, v78
    v_and_b32 v49, s8, v78
    v_lshlrev_b32 v50, 16, v79
    v_and_b32 v51, s8, v79
    v_pk_fma_f32 v[32:33], v[44:45], v[20:21], v[32:33] op_sel_hi:[1,0,1]
    v_pk_fma_f32 v[34:35], v[46:47], v[20:21], v[34:35] op_sel_hi:[1,0,1]
    v_pk_fma_f32 v[36:37], v[48:49], v[20:21], v[36:37] op_sel_hi:[1,0,1]
    v_pk_fma_f32 v[38:39], v[50:51], v[20:21], v[38:39] op_sel_hi:[1,0,1]
    s_waitcnt vmcnt(4)
    v_lshlrev_b32 v52, 16, v80
    v_and_b32 v53, s8, v80
    v_lshlrev_b32 v54, 16, v81
    v_and_b32 v55, s8, v81
    v_lshlrev_b32 v56, 16, v82
    v_and_b32 v57, s8, v82
    v_lshlrev_b32 v58, 16, v83
    v_and_b32 v59, s8, v83
    buffer_load_dwordx4 v[100:103], v5, s[48:51], s54 offen offset:2048 nt
    v_pk_fma_f32 v[32:33], v[52:53], v[20:21], v[32:33] op_sel:[0,1,0] op_sel_hi:[1,1,1]
    v_pk_fma_f32 v[34:35], v[54:55], v[20:21], v[34:35] op_sel:[0,1,0] op_sel_hi:[1,1,1]
    v_pk_fma_f32 v[36:37], v[56:57], v[20:21], v[36:37] op_sel:[0,1,0] op_sel_hi:[1,1,1]
    v_pk_fma_f32 v[38:39], v[58:59], v[20:21], v[38:39] op_sel:[0,1,0] op_sel_hi:[1,1,1]
    s_waitcnt vmcnt(4)
    v_lshlrev_b32 v44, 16, v84
    v_and_b32 v45, s8, v84
    v_lshlrev_b32 v46, 16, v85
    v_and_b32 v47, s8, v85
    v_lshlrev_b32 v48, 16, v86
    v_and_b32 v49, s8, v86
    v_lshlrev_b32 v50, 16, v87
    v_and_b32 v51, s8, v87
    buffer_load_dwordx4 v[104:107], v5, s[48:51], s54 offen offset:3072 nt
    v_pk_fma_f32 v[32:33], v[44:45], v[22:23], v[32:33] op_sel_hi:[1,0,1]
    v_pk_fma_f32 v[34:35], v[46:47], v[22:23], v[34:35] op_sel_hi:[1,0,1]
    v_pk_fma_f32 v[36:37], v[48:49], v[22:23], v[36:37] op_sel_hi:[1,0,1]
    v_pk_fma_f32 v[38:39], v[50:51], v[22:23], v[38:39] op_sel_hi:[1,0,1]
    s_waitcnt vmcnt(4)
    v_lshlrev_b32 v52, 16, v88
    v_and_b32 v53, s8, v88
    v_lshlrev_b32 v54, 16, v89
    v_and_b32 v55, s8, v89
    v_lshlrev_b32 v56, 16, v90
    v_and_b32 v57, s8, v90
    v_lshlrev_b32 v58, 16, v91
    v_and_b32 v59, s8, v91
    buffer_load_dwordx4 v[108:111], v5, s[48:51], s55 offen offset:0 nt
    v_pk_fma_f32 v[32:33], v[52:53], v[22:23], v[32:33] op_sel:[0,1,0] op_sel_hi:[1,1,1]
    v_pk_fma_f32 v[34:35], v[54:55], v[22:23], v[34:35] op_sel:[0,1,0] op_sel_hi:[1,1,1]
    v_pk_fma_f32 v[36:37], v[56:57], v[22:23], v[36:37] op_sel:[0,1,0] op_sel_hi:[1,1,1]
    v_pk_fma_f32 v[38:39], v[58:59], v[22:23], v[38:39] op_sel:[0,1,0] op_sel_hi:[1,1,1]
    s_memrealtime s[80:81]
    s_waitcnt vmcnt(4)
    v_lshlrev_b32 v44, 16, v92
    v_and_b32 v45, s8, v92
    v_lshlrev_b32 v46, 16, v93
    v_and_b32 v47, s8, v93
    v_lshlrev_b32 v48, 16, v94
    v_and_b32 v49, s8, v94
    v_lshlrev_b32 v50, 16, v95
    v_and_b32 v51, s8, v95
    buffer_load_dwordx4 v[112:115], v5, s[48:51], s55 offen offset:1024 nt
    v_pk_fma_f32 v[32:33], v[44:45], v[24:25], v[32:33] op_sel_hi:[1,0,1]
    v_pk_fma_f32 v[34:35], v[46:47], v[24:25], v[34:35] op_sel_hi:[1,0,1]
    v_pk_fma_f32 v[36:37], v[48:49], v[24:25], v[36:37] op_sel_hi:[1,0,1]
    v_pk_fma_f32 v[38:39], v[50:51], v[24:25], v[38:39] op_sel_hi:[1,0,1]
    s_waitcnt vmcnt(4)
    v_lshlrev_b32 v52, 16, v96
    v_and_b32 v53, s8, v96
    v_lshlrev_b32 v54, 16, v97
    v_and_b32 v55, s8, v97
    v_lshlrev_b32 v56, 16, v98
    v_and_b32 v57, s8, v98
    v_lshlrev_b32 v58, 16, v99
    v_and_b32 v59, s8, v99
    buffer_load_dwordx4 v[116:119], v5, s[48:51], s55 offen offset:2048 nt
    v_pk_fma_f32 v[32:33], v[52:53], v[24:25], v[32:33] op_sel:[0,1,0] op_sel_hi:[1,1,1]
    v_pk_fma_f32 v[34:35], v[54:55], v[24:25], v[34:35] op_sel:[0,1,0] op_sel_hi:[1,1,1]
    v_pk_fma_f32 v[36:37], v[56:57], v[24:25], v[36:37] op_sel:[0,1,0] op_sel_hi:[1,1,1]
    v_pk_fma_f32 v[38:39], v[58:59], v[24:25], v[38:39] op_sel:[0,1,0] op_sel_hi:[1,1,1]
    s_waitcnt vmcnt(4)
    v_lshlrev_b32 v44, 16, v100
    v_and_b32 v45, s8, v100
    v_lshlrev_b32 v46, 16, v101
    v_and_b32 v47, s8, v101
    v_lshlrev_b32 v48, 16, v102
    v_and_b32 v49, s8, v102
    v_lshlrev_b32 v50, 16, v103
    v_and_b32 v51, s8, v103
    buffer_load_dwordx4 v[120:123], v5, s[48:51], s55 offen offset:3072 nt
    v_pk_fma_f32 v[32:33], v[44:45], v[26:27], v[32:33] op_sel_hi:[1,0,1]
    v_pk_fma_f32 v[34:35], v[46:47], v[26:27], v[34:35] op_sel_hi:[1,0,1]
    v_pk_fma_f32 v[36:37], v[48:49], v[26:27], v[36:37] op_sel_hi:[1,0,1]
    v_pk_fma_f32 v[38:39], v[50:51], v[26:27], v[38:39] op_sel_hi:[1,0,1]
    s_waitcnt vmcnt(4)
    v_lshlrev_b32 v52, 16, v104
    v_and_b32 v53, s8, v104
    v_lshlrev_b32 v54, 16, v105
    v_and_b32 v55, s8, v105
    v_lshlrev_b32 v56, 16, v106
    v_and_b32 v57, s8, v106
    v_lshlrev_b32 v58, 16, v107
    v_and_b32 v59, s8, v107
    buffer_load_dwordx4 v[60:63], v5, s[48:51], s56 offen offset:0 nt
    v_pk_fma_f32 v[32:33], v[52:53], v[26:27], v[32:33] op_sel:[0,1,0] op_sel_hi:[1,1,1]
    v_pk_fma_f32 v[34:35], v[54:55], v[26:27], v[34:35] op_sel:[0,1,0] op_sel_hi:[1,1,1]
    v_pk_fma_f32 v[36:37], v[56:57], v[26:27], v[36:37] op_sel:[0,1,0] op_sel_hi:[1,1,1]
    v_pk_fma_f32 v[38:39], v[58:59], v[26:27], v[38:39] op_sel:[0,1,0] op_sel_hi:[1,1,1]
    s_waitcnt vmcnt(4)
    v_lshlrev_b32 v44, 16, v108
    v_and_b32 v45, s8, v108
    v_lshlrev_b32 v46, 16, v109
    v_and_b32 v47, s8, v109
    v_lshlrev_b32 v48, 16, v110
    v_and_b32 v49, s8, v110
    v_lshlrev_b32 v50, 16, v111
    v_and_b32 v51, s8, v111
    buffer_load_dwordx4 v[64:67], v5, s[48:51], s56 offen offset:1024 nt
    v_pk_fma_f32 v[32:33], v[44:45], v[28:29], v[32:33] op_sel_hi:[1,0,1]
    v_pk_fma_f32 v[34:35], v[46:47], v[28:29], v[34:35] op_sel_hi:[1,0,1]
    v_pk_fma_f32 v[36:37], v[48:49], v[28:29], v[36:37] op_sel_hi:[1,0,1]
    v_pk_fma_f32 v[38:39], v[50:51], v[28:29], v[38:39] op_sel_hi:[1,0,1]
    s_waitcnt vmcnt(4)
    v_lshlrev_b32 v52, 16, v112
    v_and_b32 v53, s8, v112
    v_lshlrev_b32 v54, 16, v113
    v_and_b32 v55, s8, v113
    v_lshlrev_b32 v56, 16, v114
    v_and_b32 v57, s8, v114
    v_lshlrev_b32 v58, 16, v115
    v_and_b32 v59, s8, v115
    buffer_load_dwordx4 v[68:71], v5, s[48:51], s56 offen offset:2048 nt
    v_pk_fma_f32 v[32:33], v[52:53], v[28:29], v[32:33] op_sel:[0,1,0] op_sel_hi:[1,1,1]
    v_pk_fma_f32 v[34:35], v[54:55], v[28:29], v[34:35] op_sel:[0,1,0] op_sel_hi:[1,1,1]
    v_pk_fma_f32 v[36:37], v[56:57], v[28:29], v[36:37] op_sel:[0,1,0] op_sel_hi:[1,1,1]
    v_pk_fma_f32 v[38:39], v[58:59], v[28:29], v[38:39] op_sel:[0,1,0] op_sel_hi:[1,1,1]
    s_waitcnt vmcnt(4)
    v_lshlrev_b32 v44, 16, v116
    v_and_b32 v45, s8, v116
    v_lshlrev_b32 v46, 16, v117
    v_and_b32 v47, s8, v117
    v_lshlrev_b32 v48, 16, v118
    v_and_b32 v49, s8, v118
    v_lshlrev_b32 v50, 16, v119
    v_and_b32 v51, s8, v119
    buffer_load_dwordx4 v[72:75], v5, s[48:51], s56 offen offset:3072 nt
    v_pk_fma_f32 v[32:33], v[44:45], v[30:31], v[32:33] op_sel_hi:[1,0,1]
    v_pk_fma_f32 v[34:35], v[46:47], v[30:31], v[34:35] op_sel_hi:[1,0,1]
    v_pk_fma_f32 v[36:37], v[48:49], v[30:31], v[36:37] op_sel_hi:[1,0,1]
    v_pk_fma_f32 v[38:39], v[50:51], v[30:31], v[38:39] op_sel_hi:[1,0,1]
    s_waitcnt vmcnt(4)
    v_lshlrev_b32 v52, 16, v120
    v_and_b32 v53, s8, v120
    v_lshlrev_b32 v54, 16, v121
    v_and_b32 v55, s8, v121
    v_lshlrev_b32 v56, 16, v122
    v_and_b32 v57, s8, v122
    v_lshlrev_b32 v58, 16, v123
    v_and_b32 v59, s8, v123
    buffer_load_dwordx4 v[76:79], v5, s[48:51], s57 offen offset:0 nt
    v_pk_fma_f32 v[32:33], v[52:53], v[30:31], v[32:33] op_sel:[0,1,0] op_sel_hi:[1,1,1]
    v_pk_fma_f32 v[34:35], v[54:55], v[30:31], v[34:35] op_sel:[0,1,0] op_sel_hi:[1,1,1]
    v_pk_fma_f32 v[36:37], v[56:57], v[30:31], v[36:37] op_sel:[0,1,0] op_sel_hi:[1,1,1]
    v_pk_fma_f32 v[38:39], v[58:59], v[30:31], v[38:39] op_sel:[0,1,0] op_sel_hi:[1,1,1]
    s_mov_b32 s52, s56
    s_mov_b32 s53, s57
    s_mov_b32 s54, s58
    s_mov_b32 s55, s59
    s_add_u32 s56, s56, 0x10000
    s_add_u32 s57, s57, 0x10000
    s_add_u32 s58, s58, 0x10000
    s_add_u32 s59, s59, 0x10000
    s_add_u32 s15, s15, 1
    s_waitcnt lgkmcnt(0)
    s_cmp_ge_u32 s15, 32
    s_cbranch_scc1 L_sdone
    s_sub_u32 s12, s80, s62
    s_add_u32 s62, s62, 225
    s_cmp_lt_i32 s12, 0
    s_cbranch_scc1 L_Vs0
    s_branch L_Vt01
L_Vs0:
    ds_read_b128 v[12:15], v43
    v_add_u32 v43, 0x100, v43
    s_waitcnt lgkmcnt(0)
    v_sub_f32 v12, v12, v40
    v_sub_f32 v13, v13, v40
    v_sub_f32 v14, v14, v40
    v_sub_f32 v15, v15, v40
    v_mul_f32 v12, s14, v12
    v_mul_f32 v13, s14, v13
    v_mul_f32 v14, s14, v14
    v_mul_f32 v15, s14, v15
    v_exp_f32 v12, v12
    v_exp_f32 v13, v13
    v_exp_f32 v14, v14
    v_exp_f32 v15, v15
    s_nop 0
    v_mov_b32_dpp v16, v12 row_newbcast:0 row_mask:0xf bank_mask:0xf
    v_mov_b32_dpp v17, v12 row_newbcast:8 row_mask:0xf bank_mask:0xf
    v_mov_b32_dpp v18, v12 row_newbcast:4 row_mask:0xf bank_mask:0xf
    v_mov_b32_dpp v19, v12 row_newbcast:12 row_mask:0xf bank_mask:0xf
    v_mov_b32_dpp v20, v13 row_newbcast:0 row_mask:0xf bank_mask:0xf
    v_mov_b32_dpp v21, v13 row_newbcast:8 row_mask:0xf bank_mask:0xf
    v_mov_b32_dpp v22, v13 row_newbcast:4 row_mask:0xf bank_mask:0xf
    v_mov_b32_dpp v23, v13 row_newbcast:12 row_mask:0xf bank_mask:0xf
    v_mov_b32_dpp v24, v14 row_newbcast:0 row_mask:0xf bank_mask:0xf
    v_mov_b32_dpp v25, v14 row_newbcast:8 row_mask:0xf bank_mask:0xf
    v_mov_b32_dpp v26, v14 row_newbcast:4 row_mask:0xf bank_mask:0xf
    v_mov_b32_dpp v27, v14 row_newbcast:12 row_mask:0xf bank_mask:0xf
    v_mov_b32_dpp v28, v15 row_newbcast:0 row_mask:0xf bank_mask:0xf
    v_mov_b32_dpp v29, v15 row_newbcast:8 row_mask:0xf bank_mask:0xf
    v_mov_b32_dpp v30, v15 row_newbcast:4 row_mask:0xf bank_mask:0xf
    v_mov_b32_dpp v31, v15 row_newbcast:12 row_mask:0xf bank_mask:0xf
    v_add_f32 v12, v12, v13
    v_add_f32 v14, v14, v15
    v_add_f32 v41, v41, v12
    v_add_f32 v41, v41, v14
    s_waitcnt vmcnt(4)
    v_lshlrev_b32 v44, 16, v60
    v_and_b32 v45, s8, v60
    v_lshlrev_b32 v46, 16, v61
    v_and_b32 v47, s8, v61
    v_lshlrev_b32 v48, 16, v62
    v_and_b32 v49, s8, v62
    v_lshlrev_b32 v50, 16, v63
    v_and_b32 v51, s8, v63
    buffer_load_dwordx4 v[80:83], v5, s[48:51], s53 offen offset:1024 nt
    v_pk_fma_f32 v[32:33], v[44:45], v[16:17], v[32:33] op_sel_hi:[1,0,1]
    v_pk_fma_f32 v[34:35], v[46:47], v[16:17], v[34:35] op_sel_hi:[1,0,1]
    v_pk_fma_f32 v[36:37], v[48:49], v[16:17], v[36:37] op_sel_hi:[1,0,1]
    v_pk_fma_f32 v[38:39], v[50:51], v[16:17], v[38:39] op_sel_hi:[1,0,1]
    s_waitcnt vmcnt(4)
    v_lshlrev_b32 v52, 16, v64
    v_and_b32 v53, s8, v64
    v_lshlrev_b32 v54, 16, v65
    v_and_b32 v55, s8, v65
    v_lshlrev_b32 v56, 16, v66
    v_and_b32 v57, s8, v66
    v_lshlrev_b32 v58, 16, v67
    v_and_b32 v59, s8, v67
    buffer_load_dwordx4 v[84:87], v5, s[48:51], s53 offen offset:2048 nt
    v_pk_fma_f32 v[32:33], v[52:53], v[16:17], v[32:33] op_sel:[0,1,0] op_sel_hi:[1,1,1]
    v_pk_fma_f32 v[34:35], v[54:55], v[16:17], v[34:35] op_sel:[0,1,0] op_sel_hi:[1,1,1]
    v_pk_fma_f32 v[36:37], v[56:57], v[16:17], v[36:37] op_sel:[0,1,0] op_sel_hi:[1,1,1]
    v_pk_fma_f32 v[38:39], v[58:59], v[16:17], v[38:39] op_sel:[0,1,0] op_sel_hi:[1,1,1]
    s_waitcnt vmcnt(4)
    v_lshlrev_b32 v44, 16, v68
    v_and_b32 v45, s8, v68
    v_lshlrev_b32 v46, 16, v69
    v_and_b32 v47, s8, v69
    v_lshlrev_b32 v48, 16, v70
    v_and_b32 v49, s8, v70
    v_lshlrev_b32 v50, 16, v71
    v_and_b32 v51, s8, v71
    buffer_load_dwordx4 v[88:91], v5, s[48:51], s53 offen offset:3072 nt
    v_pk_fma_f32 v[32:33], v[44:45], v[18:19], v[32:33] op_sel_hi:[1,0,1]
    v_pk_fma_f32 v[34:35], v[46:47], v[18:19], v[34:35] op_sel_hi:[1,0,1]
    v_pk_fma_f32 v[36:37], v[48:49], v[18:19], v[36:37] op_sel_hi:[1,0,1]
    v_pk_fma_f32 v[38:39], v[50:51], v[18:19], v[38:39] op_sel_hi:[1,0,1]
    s_waitcnt vmcnt(4)
    v_lshlrev_b32 v52, 16, v72
    v_and_b32 v53, s8, v72
    v_lshlrev_b32 v54, 16, v73
    v_and_b32 v55, s8, v73
    v_lshlrev_b32 v56, 16, v74
    v_and_b32 v57, s8, v74
    v_lshlrev_b32 v58, 16, v75
    v_and_b32 v59, s8, v75
    buffer_load_dwordx4 v[92:95], v5, s[48:51], s54 offen offset:0 nt
    v_pk_fma_f32 v[32:33], v[52:53], v[18:19], v[32:33] op_sel:[0,1,0] op_sel_hi:[1,1,1]
    v_pk_fma_f32 v[34:35], v[54:55], v[18:19], v[34:35] op_sel:[0,1,0] op_sel_hi:[1,1,1]
    v_pk_fma_f32 v[36:37], v[56:57], v[18:19], v[36:37] op_sel:[0,1,0] op_sel_hi:[1,1,1]
    v_pk_fma_f32 v[38:39], v[58:59], v[18:19], v[38:39] op_sel:[0,1,0] op_sel_hi:[1,1,1]
    s_waitcnt vmcnt(4)
    v_lshlrev_b32 v44, 16, v76
    v_and_b32 v45, s8, v76
    v_lshlrev_b32 v46, 16, v77
    v_and_b32 v47, s8, v77
    v_lshlrev_b32 v48, 16, v78
    v_and_b32 v49, s8, v78
    v_lshlrev_b32 v50, 16, v79
    v_and_b32 v51, s8, v79
    buffer_load_dwordx4 v[96:99], v5, s[48:51], s54 offen offset:1024 nt
    v_pk_fma_f32 v[32:33], v[44:45], v[20:21], v[32:33] op_sel_hi:[1,0,1]
    v_pk_fma_f32 v[34:35], v[46:47], v[20:21], v[34:35] op_sel_hi:[1,0,1]
    v_pk_fma_f32 v[36:37], v[48:49], v[20:21], v[36:37] op_sel_hi:[1,0,1]
    v_pk_fma_f32 v[38:39], v[50:51], v[20:21], v[38:39] op_sel_hi:[1,0,1]
    s_waitcnt vmcnt(4)
    v_lshlrev_b32 v52, 16, v80
    v_and_b32 v53, s8, v80
    v_lshlrev_b32 v54, 16, v81
    v_and_b32 v55, s8, v81
    v_lshlrev_b32 v56, 16, v82
    v_and_b32 v57, s8, v82
    v_lshlrev_b32 v58, 16, v83
    v_and_b32 v59, s8, v83
    buffer_load_dwordx4 v[100:103], v5, s[48:51], s54 offen offset:2048 nt
    v_pk_fma_f32 v[32:33], v[52:53], v[20:21], v[32:33] op_sel:[0,1,0] op_sel_hi:[1,1,1]
    v_pk_fma_f32 v[34:35], v[54:55], v[20:21], v[34:35] op_sel:[0,1,0] op_sel_hi:[1,1,1]
    v_pk_fma_f32 v[36:37], v[56:57], v[20:21], v[36:37] op_sel:[0,1,0] op_sel_hi:[1,1,1]
    v_pk_fma_f32 v[38:39], v[58:59], v[20:21], v[38:39] op_sel:[0,1,0] op_sel_hi:[1,1,1]
    s_waitcnt vmcnt(4)
    v_lshlrev_b32 v44, 16, v84
    v_and_b32 v45, s8, v84
    v_lshlrev_b32 v46, 16, v85
    v_and_b32 v47, s8, v85
    v_lshlrev_b32 v48, 16, v86
    v_and_b32 v49, s8, v86
    v_lshlrev_b32 v50, 16, v87
    v_and_b32 v51, s8, v87
    buffer_load_dwordx4 v[104:107], v5, s[48:51], s54 offen offset:3072 nt
    v_pk_fma_f32 v[32:33], v[44:45], v[22:23], v[32:33] op_sel_hi:[1,0,1]
    v_pk_fma_f32 v[34:35], v[46:47], v[22:23], v[34:35] op_sel_hi:[1,0,1]
    v_pk_fma_f32 v[36:37], v[48:49], v[22:23], v[36:37] op_sel_hi:[1,0,1]
    v_pk_fma_f32 v[38:39], v[50:51], v[22:23], v[38:39] op_sel_hi:[1,0,1]
    s_waitcnt vmcnt(4)
    v_lshlrev_b32 v52, 16, v88
    v_and_b32 v53, s8, v88
    v_lshlrev_b32 v54, 16, v89
    v_and_b32 v55, s8, v89
    v_lshlrev_b32 v56, 16, v90
    v_and_b32 v57, s8, v90
    v_lshlrev_b32 v58, 16, v91
    v_and_b32 v59, s8, v91
    buffer_load_dwordx4 v[108:111], v5, s[48:51], s55 offen offset:0 nt
    v_pk_fma_f32 v[32:33], v[52:53], v[22:23], v[32:33] op_sel:[0,1,0] op_sel_hi:[1,1,1]
    v_pk_fma_f32 v[34:35], v[54:55], v[22:23], v[34:35] op_sel:[0,1,0] op_sel_hi:[1,1,1]
    v_pk_fma_f32 v[36:37], v[56:57], v[22:23], v[36:37] op_sel:[0,1,0] op_sel_hi:[1,1,1]
    v_pk_fma_f32 v[38:39], v[58:59], v[22:23], v[38:39] op_sel:[0,1,0] op_sel_hi:[1,1,1]
    s_memrealtime s[80:81]
    s_waitcnt vmcnt(4)
    v_lshlrev_b32 v44, 16, v92
    v_and_b32 v45, s8, v92
    v_lshlrev_b32 v46, 16, v93
    v_and_b32 v47, s8, v93
    v_lshlrev_b32 v48, 16, v94
    v_and_b32 v49, s8, v94
    v_lshlrev_b32 v50, 16, v95
    v_and_b32 v51, s8, v95
    buffer_load_dwordx4 v[112:115], v5, s[48:51], s55 offen offset:1024 nt
    v_pk_fma_f32 v[32:33], v[44:45], v[24:25], v[32:33] op_sel_hi:[1,0,1]
    v_pk_fma_f32 v[34:35], v[46:47], v[24:25], v[34:35] op_sel_hi:[1,0,1]
    v_pk_fma_f32 v[36:37], v[48:49], v[24:25], v[36:37] op_sel_hi:[1,0,1]
    v_pk_fma_f32 v[38:39], v[50:51], v[24:25], v[38:39] op_sel_hi:[1,0,1]
    s_waitcnt vmcnt(4)
    v_lshlrev_b32 v52, 16, v96
    v_and_b32 v53, s8, v96
    v_lshlrev_b32 v54, 16, v97
    v_and_b32 v55, s8, v97
    v_lshlrev_b32 v56, 16, v98
    v_and_b32 v57, s8, v98
    v_lshlrev_b32 v58, 16, v99
    v_and_b32 v59, s8, v99
    buffer_load_dwordx4 v[116:119], v5, s[48:51], s55 offen offset:2048 nt
    v_pk_fma_f32 v[32:33], v[52:53], v[24:25], v[32:33] op_sel:[0,1,0] op_sel_hi:[1,1,1]
    v_pk_fma_f32 v[34:35], v[54:55], v[24:25], v[34:35] op_sel:[0,1,0] op_sel_hi:[1,1,1]
    v_pk_fma_f32 v[36:37], v[56:57], v[24:25], v[36:37] op_sel:[0,1,0] op_sel_hi:[1,1,1]
    v_pk_fma_f32 v[38:39], v[58:59], v[24:25], v[38:39] op_sel:[0,1,0] op_sel_hi:[1,1,1]
    s_waitcnt vmcnt(4)
    v_lshlrev_b32 v44, 16, v100
    v_and_b32 v45, s8, v100
    v_lshlrev_b32 v46, 16, v101
    v_and_b32 v47, s8, v101
    v_lshlrev_b32 v48, 16, v102
    v_and_b32 v49, s8, v102
    v_lshlrev_b32 v50, 16, v103
    v_and_b32 v51, s8, v103
    buffer_load_dwordx4 v[120:123], v5, s[48:51], s55 offen offset:3072 nt
    v_pk_fma_f32 v[32:33], v[44:45], v[26:27], v[32:33] op_sel_hi:[1,0,1]
    v_pk_fma_f32 v[34:35], v[46:47], v[26:27], v[34:35] op_sel_hi:[1,0,1]
    v_pk_fma_f32 v[36:37], v[48:49], v[26:27], v[36:37] op_sel_hi:[1,0,1]
    v_pk_fma_f32 v[38:39], v[50:51], v[26:27], v[38:39] op_sel_hi:[1,0,1]
    s_waitcnt vmcnt(4)
    v_lshlrev_b32 v52, 16, v104
    v_and_b32 v53, s8, v104
    v_lshlrev_b32 v54, 16, v105
    v_and_b32 v55, s8, v105
    v_lshlrev_b32 v56, 16, v106
    v_and_b32 v57, s8, v106
    v_lshlrev_b32 v58, 16, v107
    v_and_b32 v59, s8, v107
    buffer_load_dwordx4 v[60:63], v5, s[48:51], s56 offen offset:0 nt
    v_pk_fma_f32 v[32:33], v[52:53], v[26:27], v[32:33] op_sel:[0,1,0] op_sel_hi:[1,1,1]
    v_pk_fma_f32 v[34:35], v[54:55], v[26:27], v[34:35] op_sel:[0,1,0] op_sel_hi:[1,1,1]
    v_pk_fma_f32 v[36:37], v[56:57], v[26:27], v[36:37] op_sel:[0,1,0] op_sel_hi:[1,1,1]
    v_pk_fma_f32 v[38:39], v[58:59], v[26:27], v[38:39] op_sel:[0,1,0] op_sel_hi:[1,1,1]
    s_waitcnt vmcnt(4)
    v_lshlrev_b32 v44, 16, v108
    v_and_b32 v45, s8, v108
    v_lshlrev_b32 v46, 16, v109
    v_and_b32 v47, s8, v109
    v_lshlrev_b32 v48, 16, v110
    v_and_b32 v49, s8, v110
    v_lshlrev_b32 v50, 16, v111
    v_and_b32 v51, s8, v111
    buffer_load_dwordx4 v[64:67], v5, s[48:51], s56 offen offset:1024 nt
    v_pk_fma_f32 v[32:33], v[44:45], v[28:29], v[32:33] op_sel_hi:[1,0,1]
    v_pk_fma_f32 v[34:35], v[46:47], v[28:29], v[34:35] op_sel_hi:[1,0,1]
    v_pk_fma_f32 v[36:37], v[48:49], v[28:29], v[36:37] op_sel_hi:[1,0,1]
    v_pk_fma_f32 v[38:39], v[50:51], v[28:29], v[38:39] op_sel_hi:[1,0,1]
    s_waitcnt vmcnt(4)
    v_lshlrev_b32 v52, 16, v112
    v_and_b32 v53, s8, v112
    v_lshlrev_b32 v54, 16, v113
    v_and_b32 v55, s8, v113
    v_lshlrev_b32 v56, 16, v114
    v_and_b32 v57, s8, v114
    v_lshlrev_b32 v58, 16, v115
    v_and_b32 v59, s8, v115
    buffer_load_dwordx4 v[68:71], v5, s[48:51], s56 offen offset:2048 nt
    v_pk_fma_f32 v[32:33], v[52:53], v[28:29], v[32:33] op_sel:[0,1,0] op_sel_hi:[1,1,1]
    v_pk_fma_f32 v[34:35], v[54:55], v[28:29], v[34:35] op_sel:[0,1,0] op_sel_hi:[1,1,1]
    v_pk_fma_f32 v[36:37], v[56:57], v[28:29], v[36:37] op_sel:[0,1,0] op_sel_hi:[1,1,1]
    v_pk_fma_f32 v[38:39], v[58:59], v[28:29], v[38:39] op_sel:[0,1,0] op_sel_hi:[1,1,1]
    s_waitcnt vmcnt(4)
    v_lshlrev_b32 v44, 16, v116
    v_and_b32 v45, s8, v116
    v_lshlrev_b32 v46, 16, v117
    v_and_b32 v47, s8, v117
    v_lshlrev_b32 v48, 16, v118
    v_and_b32 v49, s8, v118
    v_lshlrev_b32 v50, 16, v119
    v_and_b32 v51, s8, v119
    buffer_load_dwordx4 v[72:75], v5, s[48:51], s56 offen offset:3072 nt
    v_pk_fma_f32 v[32:33], v[44:45], v[30:31], v[32:33] op_sel_hi:[1,0,1]
    v_pk_fma_f32 v[34:35], v[46:47], v[30:31], v[34:35] op_sel_hi:[1,0,1]
    v_pk_fma_f32 v[36:37], v[48:49], v[30:31], v[36:37] op_sel_hi:[1,0,1]
    v_pk_fma_f32 v[38:39], v[50:51], v[30:31], v[38:39] op_sel_hi:[1,0,1]
    s_waitcnt vmcnt(4)
    v_lshlrev_b32 v52, 16, v120
    v_and_b32 v53, s8, v120
    v_lshlrev_b32 v54, 16, v121
    v_and_b32 v55, s8, v121
    v_lshlrev_b32 v56, 16, v122
    v_and_b32 v57, s8, v122
    v_lshlrev_b32 v58, 16, v123
    v_and_b32 v59, s8, v123
    buffer_load_dwordx4 v[76:79], v5, s[48:51], s57 offen offset:0 nt
    v_pk_fma_f32 v[32:33], v[52:53], v[30:31], v[32:33] op_sel:[0,1,0] op_sel_hi:[1,1,1]
    v_pk_fma_f32 v[34:35], v[54:55], v[30:31], v[34:35] op_sel:[0,1,0] op_sel_hi:[1,1,1]
    v_pk_fma_f32 v[36:37], v[56:57], v[30:31], v[36:37] op_sel:[0,1,0] op_sel_hi:[1,1,1]
    v_pk_fma_f32 v[38:39], v[58:59], v[30:31], v[38:39] op_sel:[0,1,0] op_sel_hi:[1,1,1]
    s_mov_b32 s52, s56
    s_mov_b32 s53, s57
    s_mov_b32 s54, s58
    s_mov_b32 s55, s59
    s_add_u32 s56, s56, 0x10000
    s_add_u32 s57, s57, 0x10000
    s_add_u32 s58, s58, 0x10000
    s_add_u32 s59, s59, 0x10000
    s_add_u32 s15, s15, 1
    s_waitcnt lgkmcnt(0)
    s_cmp_ge_u32 s15, 32
    s_cbranch_scc1 L_sdone
    s_sub_u32 s12, s80, s62
    s_add_u32 s62, s62, 225
    s_cmp_lt_i32 s12, 0
    s_cbranch_scc1 L_Vs0
    s_branch L_Vt01
L_kv0:
    s_cmp_eq_u32 s15, 16
    s_cbranch_scc1 L_kv0b
    s_mov_b32 s68, s48
    s_mov_b32 s69, s49
    s_mov_b32 s56, 0
    s_mov_b32 s58, 8192
    s_mov_b32 s57, 4096
    s_mov_b32 s59, 12288
    s_sub_u32 s12, s80, s62
    s_add_u32 s62, s62, 225
    s_cmp_lt_i32 s12, 0
    s_cbranch_scc1 L_Ks0
    s_branch L_Kt01
L_kv0b:
    v_max_f32_dpp v40, v40, v40 row_ror:4 row_mask:0xf bank_mask:0xf
    v_subrev_u32 v43, 0x1000, v43
    s_nop 0
    v_max_f32_dpp v40, v40, v40 row_ror:8 row_mask:0xf bank_mask:0xf
    s_sub_u32 s12, s80, s62
    s_add_u32 s62, s62, 225
    s_cmp_lt_i32 s12, 0
    s_cbranch_scc1 L_Vs0
    s_branch L_Vt01
L_kv1:
    s_cmp_eq_u32 s15, 16
    s_cbranch_scc1 L_kv1b
    s_mov_b32 s68, s48
    s_mov_b32 s69, s49
    s_mov_b32 s56, 0
    s_mov_b32 s58, 8192
    s_mov_b32 s57, 4096
    s_mov_b32 s59, 12288
    s_sub_u32 s12, s80, s62
    s_add_u32 s62, s62, 225
    s_cmp_lt_i32 s12, 0
    s_cbranch_scc1 L_Kt10
    s_branch L_Ks1
L_kv1b:
    v_max_f32_dpp v40, v40, v40 row_ror:4 row_mask:0xf bank_mask:0xf
    v_subrev_u32 v43, 0x1000, v43
    s_nop 0
    v_max_f32_dpp v40, v40, v40 row_ror:8 row_mask:0xf bank_mask:0xf
    s_sub_u32 s12, s80, s62
    s_add_u32 s62, s62, 225
    s_cmp_lt_i32 s12, 0
    s_cbranch_scc1 L_Vt10
    s_branch L_Vs1
L_sdone:
    v_add_f32_dpp v41, v41, v41 row_ror:4 row_mask:0xf bank_mask:0xf
    s_lshl_b32 s12, s3, 2
    v_add_u32 v7, s12, v4
    v_lshlrev_b32 v9, 9, v7
    v_add_u32 v9, v9, v6
    v_add_f32_dpp v41, v41, v41 row_ror:8 row_mask:0xf bank_mask:0xf
    ds_write_b128 v9, v[32:35] offset:4096
    ds_write_b128 v9, v[36:39] offset:4112
    v_lshlrev_b32 v7, 3, v7
    v_cmp_eq_u32 vcc, 0, v3
    s_and_saveexec_b64 s[60:61], vcc
    ds_write_b64 v7, v[40:41] offset:512
    s_mov_b64 exec, s[60:61]
    s_waitcnt lgkmcnt(0)
    s_barrier
    s_endpgm
L_aux:
    s_setprio 3
    s_sub_u32 s9, s3, 4
    v_cmp_lt_u32 s[4:5], 7, v3
    v_and_b32 v5, 7, v3
    v_lshrrev_b32 v62, 3, v2
    v_lshlrev_b32 v63, 4, v5
    v_lshl_add_u32 v9, v62, 13, v63
    v_mul_u32_u24 v12, 7168, v62
    v_add_u32 v12, v12, v63
    v_lshl_add_u32 v10, v62, 11, v63
    v_lshlrev_b32 v13, 11, v5
    v_lshl_add_u32 v13, v4, 4, v13
    s_lshr_b32 s12, s7, 1
    s_lshl_b32 s12, s12, 2
    s_add_u32 s12, s12, s9
    s_lshl_b32 s88, s12, 19
    s_lshl_b32 s84, s12, 7
    s_lshl_b32 s10, s6, 8
    s_add_u32 s88, s88, s10
    s_and_b32 s12, s7, 1
    s_lshl_b32 s12, s12, 7
    s_add_u32 s88, s88, s12
    s_lshl_b32 s91, s9, 13
    s_add_u32 s91, s91, 12288
    s_cmp_lg_u32 s9, 0
    s_waitcnt lgkmcnt(0)
    s_mov_b32 s52, s40
    s_mov_b32 s53, s41
    s_mov_b32 s54, 0x2b0000
    s_mov_b32 s55, 0x00020000
    s_mov_b32 s48, s16
    s_mov_b32 s49, s17
    s_mov_b32 s50, 0x4000
    s_mov_b32 s51, 0x00020000
    s_mov_b32 s44, s22
    s_mov_b32 s45, s23
    s_mov_b32 s46, 0x800000
    s_mov_b32 s47, 0x00020000
    s_cbranch_scc1 L_a1
    v_lshrrev_b32 v62, 3, v3
    v_lshlrev_b32 v63, 5, v62
    v_lshl_add_u32 v63, v4, 3, v63
    v_mul_u32_u24 v47, 7168, v5
    v_add_u32 v47, v47, v63
    v_lshlrev_b32 v62, 6, v62
    v_lshl_add_u32 v62, v4, 4, v62
    v_lshl_add_u32 v6, v5, 17, v62
    v_lshl_add_u32 v7, v5, 11, v62
    v_lshlrev_b32 v8, 2, v2
    v_lshlrev_b32 v40, 4, v2
    s_lshl_b32 s12, s6, 3
    s_add_u32 s12, s12, s7
    s_lshl_b32 s86, s12, 7
    s_add_u32 s86, s86, 0x20000
    s_lshl_b32 s82, s12, 8
    s_add_u32 s82, s82, 0x10000
    s_lshl_b32 s81, s12, 11
    s_add_u32 s81, s81, 0x80000
    s_lshl_b32 s83, s6, 14
    s_lshl_b32 s12, s7, 8
    s_add_u32 s83, s83, s12
    s_add_u32 s83, s83, 0x80000
    s_and_b32 s12, s6, 15
    s_lshl_b32 s80, s12, 12
    s_lshl_b32 s12, s7, 1
    s_lshr_b32 s13, s6, 4
    s_add_u32 s12, s12, s13
    s_lshl_b32 s12, s12, 8
    s_add_u32 s80, s80, s12
    s_add_u32 s80, s80, 0x100000
    s_lshl_b32 s87, s15, 7
    s_mul_i32 s26, s15, 12288
    s_add_u32 s26, s26, 0x200000
    s_cmp_lt_u32 s7, 7
    s_cselect_b32 s13, 0x2b0000, 0
    s_mov_b32 s72, s40
    s_mov_b32 s73, s41
    s_mov_b32 s74, s13
    s_mov_b32 s75, 0x00020000
    s_cmp_eq_u32 s99, 0
    s_cselect_b32 s12, s13, 0
    s_cselect_b32 s13, 0, s13
    s_mov_b32 s16, s40
    s_mov_b32 s17, s41
    s_mov_b32 s18, s12
    s_mov_b32 s19, 0x00020000
    s_mov_b32 s20, s40
    s_mov_b32 s21, s41
    s_mov_b32 s22, s13
    s_mov_b32 s23, 0x00020000
    s_lshl_b32 s12, s99, 12
    s_add_u32 s10, s26, s12
    s_sub_u32 s10, s10, 4096
    s_add_u32 s13, s80, 0x10000
    v_mov_b32 v32, -1
    v_mov_b32 v33, -1
    v_mov_b32 v34, -1
    v_mov_b32 v35, -1
    v_mov_b32 v60, 0
    v_mov_b32 v61, 0
    buffer_store_dwordx4 v[32:35], v7, s[52:55], s83 offen sc1
    buffer_store_dwordx4 v[32:35], v7, s[52:55], s83 offen offset:128 sc1
    buffer_store_dwordx2 v[60:61], off, s[52:55], s86 sc1
    buffer_store_dwordx2 v[32:33], v47, s[16:19], s87 offen sc1
    buffer_store_dwordx2 v[32:33], v47, s[16:19], s87 offen offset:64 sc1
    buffer_store_dwordx4 v[32:35], v40, s[20:23], s10 offen offset:0 sc1
    buffer_store_dwordx4 v[32:35], v40, s[20:23], s10 offen offset:1024 sc1
    buffer_store_dwordx4 v[32:35], v40, s[20:23], s10 offen offset:2048 sc1
    buffer_store_dwordx4 v[32:35], v40, s[20:23], s10 offen offset:3072 sc1
    buffer_store_dwordx4 v[32:35], v6, s[52:55], s80 offen sc1
    buffer_store_dwordx4 v[32:35], v6, s[52:55], s80 offen offset:128 sc1
    buffer_store_dwordx4 v[32:35], v6, s[52:55], s13 offen sc1
    buffer_store_dwordx4 v[32:35], v6, s[52:55], s13 offen offset:128 sc1
    buffer_store_dword v32, v8, s[52:55], s82 offen sc1
L_a1:
    buffer_load_dwordx4 v[16:19], v13, s[48:51], s84 offen offset:0
    buffer_load_dwordx4 v[20:23], v13, s[48:51], s84 offen offset:64
    s_add_u32 m0, s91, 0
    s_add_u32 s11, s88, 0
    buffer_load_dwordx4 v9, s[44:47], s11 offen nt lds
    s_add_u32 m0, s91, 1024
    s_add_u32 s11, s88, 65536
    buffer_load_dwordx4 v9, s[44:47], s11 offen nt lds
    s_add_u32 m0, s91, 2048
    s_add_u32 s11, s88, 131072
    buffer_load_dwordx4 v9, s[44:47], s11 offen nt lds
    s_add_u32 m0, s91, 3072
    s_add_u32 s11, s88, 196608
    buffer_load_dwordx4 v9, s[44:47], s11 offen nt lds
    s_add_u32 m0, s91, 4096
    s_add_u32 s11, s88, 262144
    buffer_load_dwordx4 v9, s[44:47], s11 offen nt lds
    s_add_u32 m0, s91, 5120
    s_add_u32 s11, s88, 327680
    buffer_load_dwordx4 v9, s[44:47], s11 offen nt lds
    s_add_u32 m0, s91, 6144
    s_add_u32 s11, s88, 393216
    buffer_load_dwordx4 v9, s[44:47], s11 offen nt lds
    s_add_u32 m0, s91, 7168
    s_add_u32 s11, s88, 458752
    buffer_load_dwordx4 v9, s[44:47], s11 offen nt lds
    s_cmp_lg_u32 s9, 0
    s_cbranch_scc1 L_a1b
    s_waitcnt vmcnt(10)
L_a1b:
    s_barrier
    s_mov_b32 s76, s38
    s_mov_b32 s77, s39
    s_mov_b32 s78, 0x100
    s_mov_b32 s79, 0x00020000
    v_mov_b32 v60, 0
    v_mov_b32 v61, 1
    s_cmp_lg_u32 s9, 0
    s_cbranch_scc1 L_a2
    s_waitcnt vmcnt(10)
    s_lshl_b32 s13, s6, 2
    v_mov_b32 v41, 1
    s_mov_b64 exec, 1
    buffer_atomic_add v41, off, s[76:79], s13 sc0 sc1
    s_mov_b64 exec, -1
L_a2:
    v_lshrrev_b32 v62, 3, v3
    v_lshlrev_b32 v63, 5, v62
    v_lshl_add_u32 v63, v4, 3, v63
    v_mul_u32_u24 v47, 7168, v5
    v_add_u32 v47, v47, v63
    v_lshlrev_b32 v62, 6, v62
    v_lshl_add_u32 v62, v4, 4, v62
    v_lshl_add_u32 v6, v5, 17, v62
    v_lshl_add_u32 v7, v5, 11, v62
    v_lshlrev_b32 v8, 2, v2
    v_lshlrev_b32 v40, 4, v2
    s_lshl_b32 s12, s6, 3
    s_add_u32 s12, s12, s7
    s_lshl_b32 s86, s12, 7
    s_add_u32 s86, s86, 0x20000
    s_lshl_b32 s82, s12, 8
    s_add_u32 s82, s82, 0x10000
    s_lshl_b32 s81, s12, 11
    s_add_u32 s81, s81, 0x80000
    s_lshl_b32 s83, s6, 14
    s_lshl_b32 s12, s7, 8
    s_add_u32 s83, s83, s12
    s_add_u32 s83, s83, 0x80000
    s_and_b32 s12, s6, 15
    s_lshl_b32 s80, s12, 12
    s_lshl_b32 s12, s7, 1
    s_lshr_b32 s13, s6, 4
    s_add_u32 s12, s12, s13
    s_lshl_b32 s12, s12, 8
    s_add_u32 s80, s80, s12
    s_add_u32 s80, s80, 0x100000
    s_lshl_b32 s87, s15, 7
    s_mul_i32 s26, s15, 12288
    s_add_u32 s26, s26, 0x200000
    s_cmp_lt_u32 s7, 7
    s_cselect_b32 s13, 0x2b0000, 0
    s_mov_b32 s72, s40
    s_mov_b32 s73, s41
    s_mov_b32 s74, s13
    s_mov_b32 s75, 0x00020000
    s_cmp_eq_u32 s99, 0
    s_cselect_b32 s12, s13, 0
    s_cselect_b32 s13, 0, s13
    s_mov_b32 s16, s40
    s_mov_b32 s17, s41
    s_mov_b32 s18, s12
    s_mov_b32 s19, 0x00020000
    s_mov_b32 s20, s40
    s_mov_b32 s21, s41
    s_mov_b32 s22, s13
    s_mov_b32 s23, 0x00020000
    s_lshl_b32 s12, s99, 12
    s_add_u32 s10, s26, s12
    s_sub_u32 s10, s10, 4096
    s_add_u32 s13, s80, 0x10000
    v_bfe_u32 v62, v2, 2, 2
    v_and_b32 v63, 3, v2
    v_lshlrev_b32 v49, 10, v4
    v_lshl_add_u32 v49, v62, 7, v49
    v_lshl_add_u32 v49, v63, 3, v49
    v_add_u32 v49, s91, v49
    v_add_u32 v48, 0x10000, v49
    v_add_u32 v11, s91, v40
    v_add_u32 v45, 0x10000, v11
    v_add_u32 v50, 12288, v40
    v_add_u32 v51, 0x10000, v50
    s_lshl_b32 s13, s9, 11
    v_add_u32 v39, s13, v40
    s_cmp_lg_u32 s9, 0
    s_cbranch_scc1 L_a2b
    s_waitcnt vmcnt(1)
    s_branch L_a2c
L_a2b:
    s_waitcnt vmcnt(0)
L_a2c:
    ds_read_b64_tr_b16 v[96:97], v49 offset:0
    ds_read_b64_tr_b16 v[98:99], v49 offset:512
    ds_read_b64_tr_b16 v[100:101], v49 offset:4096
    ds_read_b64_tr_b16 v[102:103], v49 offset:4608
    ds_read_b64_tr_b16 v[104:105], v49 offset:32
    ds_read_b64_tr_b16 v[106:107], v49 offset:544
    ds_read_b64_tr_b16 v[108:109], v49 offset:4128
    ds_read_b64_tr_b16 v[110:111], v49 offset:4640
    ds_read_b64_tr_b16 v[112:113], v49 offset:64
    ds_read_b64_tr_b16 v[114:115], v49 offset:576
    ds_read_b64_tr_b16 v[116:117], v49 offset:4160
    ds_read_b64_tr_b16 v[118:119], v49 offset:4672
    ds_read_b64_tr_b16 v[120:121], v49 offset:96
    ds_read_b64_tr_b16 v[122:123], v49 offset:608
    ds_read_b64_tr_b16 v[124:125], v49 offset:4192
    ds_read_b64_tr_b16 v[126:127], v49 offset:4704
    s_mov_b32 s43, 0
    s_mov_b32 s84, 0
    s_waitcnt lgkmcnt(0)
    v_mfma_f32_16x16x32_bf16 v[208:211], v[96:99], v[16:19], 0
    v_mfma_f32_16x16x32_bf16 v[212:215], v[104:107], v[16:19], 0
    v_mfma_f32_16x16x32_bf16 v[216:219], v[112:115], v[16:19], 0
    v_mfma_f32_16x16x32_bf16 v[220:223], v[120:123], v[16:19], 0
    v_mfma_f32_16x16x32_bf16 v[208:211], v[100:103], v[20:23], v[208:211]
    v_mfma_f32_16x16x32_bf16 v[212:215], v[108:111], v[20:23], v[212:215]
    v_mfma_f32_16x16x32_bf16 v[216:219], v[116:119], v[20:23], v[216:219]
    v_mfma_f32_16x16x32_bf16 v[220:223], v[124:127], v[20:23], v[220:223]
    s_nop 5
    v_cndmask_b32 v24, v208, v212, s[4:5]
    v_cndmask_b32 v25, v209, v213, s[4:5]
    v_cndmask_b32 v26, v210, v214, s[4:5]
    v_cndmask_b32 v27, v211, v215, s[4:5]
    v_cndmask_b32 v28, v216, v220, s[4:5]
    v_cndmask_b32 v29, v217, v221, s[4:5]
    v_cndmask_b32 v30, v218, v222, s[4:5]
    v_cndmask_b32 v31, v219, v223, s[4:5]
    ds_write_b128 v39, v[24:27] offset:4096
    ds_write_b128 v39, v[28:31] offset:5120
    s_mov_b64 exec, 1
    s_waitcnt lgkmcnt(0)
    ds_add_rtn_u32 v62, v60, v61 offset:256
    s_waitcnt lgkmcnt(0)
    v_readfirstlane_b32 s12, v62
    s_mov_b64 exec, -1
    s_cmp_lg_u32 s12, 3
    s_cbranch_scc1 L_a4
    ds_read_b128 v[96:99], v40 offset:4096
    ds_read_b128 v[100:103], v40 offset:5120
    ds_read_b128 v[104:107], v40 offset:6144
    ds_read_b128 v[108:111], v40 offset:7168
    ds_read_b128 v[112:115], v40 offset:8192
    ds_read_b128 v[116:119], v40 offset:9216
    ds_read_b128 v[120:123], v40 offset:10240
    ds_read_b128 v[124:127], v40 offset:11264
    s_waitcnt lgkmcnt(0)
    v_add_f32 v96, v96, v104
    v_add_f32 v112, v112, v120
    v_add_f32 v97, v97, v105
    v_add_f32 v113, v113, v121
    v_add_f32 v98, v98, v106
    v_add_f32 v114, v114, v122
    v_add_f32 v99, v99, v107
    v_add_f32 v115, v115, v123
    v_add_f32 v100, v100, v108
    v_add_f32 v116, v116, v124
    v_add_f32 v101, v101, v109
    v_add_f32 v117, v117, v125
    v_add_f32 v102, v102, v110
    v_add_f32 v118, v118, v126
    v_add_f32 v103, v103, v111
    v_add_f32 v119, v119, v127
    v_add_f32 v96, v96, v112
    v_add_f32 v97, v97, v113
    v_add_f32 v98, v98, v114
    v_add_f32 v99, v99, v115
    v_add_f32 v100, v100, v116
    v_add_f32 v101, v101, v117
    v_add_f32 v102, v102, v118
    v_add_f32 v103, v103, v119
    v_min_u32 v96, -2, v96
    v_min_u32 v97, -2, v97
    v_min_u32 v98, -2, v98
    v_min_u32 v99, -2, v99
    v_min_u32 v100, -2, v100
    v_min_u32 v101, -2, v101
    v_min_u32 v102, -2, v102
    v_min_u32 v103, -2, v103
    buffer_store_dwordx4 v[96:99], v7, s[52:55], s83 offen sc1
    buffer_store_dwordx4 v[100:103], v7, s[52:55], s83 offen offset:128 sc1
    s_mov_b32 s84, 1
L_a4:
    s_cmp_lt_u32 s7, 7
    s_cselect_b32 s13, 0x700000, 0
    s_mov_b32 s56, s28
    s_mov_b32 s57, s29
    s_mov_b32 s58, s13
    s_mov_b32 s59, 0x00020000
    s_mov_b32 s60, s30
    s_mov_b32 s61, s31
    s_mov_b32 s62, s13
    s_mov_b32 s63, 0x00020000
    s_mov_b32 s64, s32
    s_mov_b32 s65, s33
    s_mov_b32 s66, s13
    s_mov_b32 s67, 0x00020000
    s_mov_b32 s68, s24
    s_mov_b32 s69, s25
    s_mov_b32 s70, 0x800000
    s_mov_b32 s71, 0x00020000
    s_mov_b32 s28, s10
    s_lshl_b32 s12, s99, 2
    s_add_u32 s12, s12, s9
    s_lshl_b32 s27, s12, 7
    s_mul_i32 s89, s12, 458752
    s_add_u32 s89, s89, s87
    s_lshl_b32 s12, s7, 1
    s_lshr_b32 s13, s6, 4
    s_add_u32 s12, s12, s13
    s_lshl_b32 s12, s12, 2
    s_add_u32 s12, s12, s9
    s_lshl_b32 s90, s12, 17
    s_and_b32 s13, s6, 15
    s_lshl_b32 s29, s13, 7
    s_add_u32 s90, s90, s29
    s_lshl_b32 s85, s12, 7
    s_lshr_b32 s13, s12, 1
    s_lshl_b32 s42, s13, 11
    s_and_b32 s13, s12, 1
    s_lshl_b32 s13, s13, 7
    s_add_u32 s42, s42, s13
    s_add_u32 s42, s42, 0x10000
    s_lshl_b32 s14, s7, 5
    s_add_u32 s14, s14, s6
    s_lshl_b32 s14, s14, 12
    s_add_u32 s14, s14, 0x100000
    s_lshl_b32 s15, s7, 11
    s_add_u32 s15, s15, s29
    s_lshr_b32 s13, s6, 4
    s_lshl_b32 s13, s13, 6
    s_add_u32 s15, s15, s13
    s_add_u32 s30, s80, 0x10000
    v_mov_b32 v1, 0x7ffffff0
    v_lshlrev_b32 v42, 3, v5
    v_lshl_add_u32 v42, v4, 1, v42
    v_cndmask_b32 v42, v42, v1, s[4:5]
    v_lshlrev_b32 v43, 3, v3
    v_lshlrev_b32 v0, 3, v2
    v_lshlrev_b32 v14, 8, v5
    v_lshl_add_u32 v14, v4, 4, v14
    v_mul_u32_u24 v15, 7168, v5
    v_lshl_add_u32 v15, v4, 4, v15
    s_cmp_lg_u32 s9, 0
    s_cbranch_scc1 L_a5
    s_waitcnt vmcnt(2)
    s_cmp_lg_u32 s84, 0
    s_cbranch_scc1 L_a4b
    s_waitcnt vmcnt(0)
L_a4b:
    v_readfirstlane_b32 s12, v41
    s_nop 1
    s_and_b32 s12, s12, 7
    s_cmp_lg_u32 s12, 7
    s_cbranch_scc1 L_a3
    v_lshlrev_b32 v62, 7, v2
    s_lshl_b32 s13, s6, 10
    s_add_u32 s13, s13, 0x20000
    s_mov_b64 exec, 0xff
    buffer_store_dword v61, v62, s[52:55], s13 offen sc1
    s_mov_b64 exec, 1
    v_mov_b32 v41, 1
    buffer_atomic_add v41, off, s[76:79], 0 offset:128 sc0 sc1
    s_mov_b32 s43, 2
    s_mov_b64 exec, -1
L_a3:
    s_mov_b32 s12, 0
L_go1:
    buffer_load_dword v62, off, s[52:55], s86 offset:0 sc1
    s_waitcnt vmcnt(0)
    v_readfirstlane_b32 s10, v62
    s_nop 1
    s_cmp_lg_u32 s10, 0
    s_cbranch_scc1 L_go1_done
    s_sleep 1
    s_add_u32 s12, s12, 1
    s_cmp_lt_u32 s12, 50000
    s_cbranch_scc1 L_go1
L_go1_done:
    s_mov_b32 s12, 0
L_pollQ:
    buffer_load_dwordx4 v[192:195], v40, s[52:55], s81 offen offset:0 sc1
    buffer_load_dwordx4 v[196:199], v40, s[52:55], s81 offen offset:1024 sc1
    s_waitcnt vmcnt(0)
    v_max3_u32 v60, v192, v193, v194
    v_max3_u32 v61, v195, v196, v197
    v_max3_u32 v60, v60, v198, v199
    v_max_u32 v60, v60, v61
    v_cmp_eq_u32 vcc, -1, v60
    s_cbranch_vccz L_pollQ_done
    s_mov_b64 exec, vcc
    s_sleep 1
    s_add_u32 s12, s12, 1
    s_cmp_lt_u32 s12, 50000
    s_cbranch_scc1 L_pollQ
L_pollQ_done:
    s_mov_b64 exec, -1
    v_add_f32 v192, v192, v196
    v_add_f32 v193, v193, v197
    v_add_f32 v194, v194, v198
    v_add_f32 v195, v195, v199
    v_and_b32 v63, 31, v2
    v_lshlrev_b32 v63, 3, v63
    v_permlane32_swap_b32 v192, v194
    v_permlane32_swap_b32 v193, v195
    v_add_f32 v192, v192, v194
    v_add_f32 v193, v193, v195
    v_cvt_pk_bf16_f32 v62, v192, v193
    v_lshrrev_b32 v36, 5, v2
    v_lshl_add_u32 v63, v36, 2, v63
    ds_write_b32 v63, v62 offset:0
    v_mov_b32 v60, 0
    v_mov_b32 v61, 1
    s_waitcnt lgkmcnt(0)
    ds_write_b32 v60, v61 offset:264
    s_cmp_lg_u32 s43, 2
    s_cbranch_scc1 L_a5
    v_readfirstlane_b32 s12, v41
    s_nop 1
    s_and_b32 s12, s12, 31
    s_cmp_lg_u32 s12, 31
    s_cbranch_scc1 L_a5
    v_lshlrev_b32 v62, 7, v2
    s_mov_b32 s13, 0x20000
    buffer_store_dword v61, v62, s[52:55], s13 offen offset:4 sc1
    s_mov_b32 s13, 0x22000
    buffer_store_dword v61, v62, s[52:55], s13 offen offset:4 sc1
    s_mov_b32 s13, 0x24000
    buffer_store_dword v61, v62, s[52:55], s13 offen offset:4 sc1
    s_mov_b32 s13, 0x26000
    buffer_store_dword v61, v62, s[52:55], s13 offen offset:4 sc1
L_a5:
    s_setprio 0
    buffer_load_dwordx4 v[16:19], v13, s[48:51], s27 offen offset:0
    buffer_load_dwordx4 v[20:23], v13, s[48:51], s27 offen offset:64
    s_add_u32 m0, s91, 32768
    s_add_u32 s11, s89, 0
    buffer_load_dwordx4 v12, s[56:59], s11 offen nt lds
    s_add_u32 m0, s91, 33792
    s_add_u32 s11, s89, 57344
    buffer_load_dwordx4 v12, s[56:59], s11 offen nt lds
    s_add_u32 m0, s91, 34816
    s_add_u32 s11, s89, 114688
    buffer_load_dwordx4 v12, s[56:59], s11 offen nt lds
    s_add_u32 m0, s91, 35840
    s_add_u32 s11, s89, 172032
    buffer_load_dwordx4 v12, s[56:59], s11 offen nt lds
    s_add_u32 m0, s91, 36864
    s_add_u32 s11, s89, 229376
    buffer_load_dwordx4 v12, s[56:59], s11 offen nt lds
    s_add_u32 m0, s91, 37888
    s_add_u32 s11, s89, 286720
    buffer_load_dwordx4 v12, s[56:59], s11 offen nt lds
    s_add_u32 m0, s91, 38912
    s_add_u32 s11, s89, 344064
    buffer_load_dwordx4 v12, s[56:59], s11 offen nt lds
    s_add_u32 m0, s91, 39936
    s_add_u32 s11, s89, 401408
    buffer_load_dwordx4 v12, s[56:59], s11 offen nt lds
    s_add_u32 m0, s91, 65536
    s_add_u32 s11, s89, 0
    buffer_load_dwordx4 v12, s[60:63], s11 offen nt lds
    s_add_u32 m0, s91, 66560
    s_add_u32 s11, s89, 57344
    buffer_load_dwordx4 v12, s[60:63], s11 offen nt lds
    s_add_u32 m0, s91, 67584
    s_add_u32 s11, s89, 114688
    buffer_load_dwordx4 v12, s[60:63], s11 offen nt lds
    s_add_u32 m0, s91, 68608
    s_add_u32 s11, s89, 172032
    buffer_load_dwordx4 v12, s[60:63], s11 offen nt lds
    s_add_u32 m0, s91, 69632
    s_add_u32 s11, s89, 229376
    buffer_load_dwordx4 v12, s[60:63], s11 offen nt lds
    s_add_u32 m0, s91, 70656
    s_add_u32 s11, s89, 286720
    buffer_load_dwordx4 v12, s[60:63], s11 offen nt lds
    s_add_u32 m0, s91, 71680
    s_add_u32 s11, s89, 344064
    buffer_load_dwordx4 v12, s[60:63], s11 offen nt lds
    s_add_u32 m0, s91, 72704
    s_add_u32 s11, s89, 401408
    buffer_load_dwordx4 v12, s[60:63], s11 offen nt lds
    s_add_u32 m0, s91, 0
    s_add_u32 s11, s90, 0
    buffer_load_dwordx4 v10, s[68:71], s11 offen nt lds
    s_add_u32 m0, s91, 1024
    s_add_u32 s11, s90, 16384
    buffer_load_dwordx4 v10, s[68:71], s11 offen nt lds
    s_add_u32 m0, s91, 2048
    s_add_u32 s11, s90, 32768
    buffer_load_dwordx4 v10, s[68:71], s11 offen nt lds
    s_add_u32 m0, s91, 3072
    s_add_u32 s11, s90, 49152
    buffer_load_dwordx4 v10, s[68:71], s11 offen nt lds
    s_add_u32 m0, s91, 4096
    s_add_u32 s11, s90, 65536
    buffer_load_dwordx4 v10, s[68:71], s11 offen nt lds
    s_add_u32 m0, s91, 5120
    s_add_u32 s11, s90, 81920
    buffer_load_dwordx4 v10, s[68:71], s11 offen nt lds
    s_add_u32 m0, s91, 6144
    s_add_u32 s11, s90, 98304
    buffer_load_dwordx4 v10, s[68:71], s11 offen nt lds
    s_add_u32 m0, s91, 7168
    s_add_u32 s11, s90, 114688
    buffer_load_dwordx4 v10, s[68:71], s11 offen nt lds
    s_add_u32 m0, s91, 98304
    s_add_u32 s11, s90, 0
    buffer_load_dwordx4 v10, s[64:67], s11 offen nt lds
    s_add_u32 m0, s91, 99328
    s_add_u32 s11, s90, 16384
    buffer_load_dwordx4 v10, s[64:67], s11 offen nt lds
    s_add_u32 m0, s91, 100352
    s_add_u32 s11, s90, 32768
    buffer_load_dwordx4 v10, s[64:67], s11 offen nt lds
    s_add_u32 m0, s91, 101376
    s_add_u32 s11, s90, 49152
    buffer_load_dwordx4 v10, s[64:67], s11 offen nt lds
    s_add_u32 m0, s91, 102400
    s_add_u32 s11, s90, 65536
    buffer_load_dwordx4 v10, s[64:67], s11 offen nt lds
    s_add_u32 m0, s91, 103424
    s_add_u32 s11, s90, 81920
    buffer_load_dwordx4 v10, s[64:67], s11 offen nt lds
    s_add_u32 m0, s91, 104448
    s_add_u32 s11, s90, 98304
    buffer_load_dwordx4 v10, s[64:67], s11 offen nt lds
    s_add_u32 m0, s91, 105472
    s_add_u32 s11, s90, 114688
    buffer_load_dwordx4 v10, s[64:67], s11 offen nt lds
    s_mov_b32 s44, s34
    s_mov_b32 s45, s35
    s_mov_b32 s46, 0x800
    s_mov_b32 s47, 0x00020000
    s_lshl_b32 s13, s7, 11
    v_lshlrev_b32 v5, 5, v2
    buffer_load_dwordx4 v[192:195], v5, s[48:51], s13 offen
    buffer_load_dwordx4 v[196:199], v5, s[48:51], s13 offen offset:16
    buffer_load_dwordx4 v[200:203], v5, s[44:47], 0 offen
    buffer_load_dwordx4 v[204:207], v5, s[44:47], 0 offen offset:16
    s_waitcnt vmcnt(20)
    ds_read_b64_tr_b16 v[96:97], v49 offset:32768
    ds_read_b64_tr_b16 v[98:99], v49 offset:33280
    ds_read_b64_tr_b16 v[100:101], v49 offset:36864
    ds_read_b64_tr_b16 v[102:103], v49 offset:37376
    ds_read_b64_tr_b16 v[104:105], v49 offset:32800
    ds_read_b64_tr_b16 v[106:107], v49 offset:33312
    ds_read_b64_tr_b16 v[108:109], v49 offset:36896
    ds_read_b64_tr_b16 v[110:111], v49 offset:37408
    ds_read_b64_tr_b16 v[112:113], v49 offset:32832
    ds_read_b64_tr_b16 v[114:115], v49 offset:33344
    ds_read_b64_tr_b16 v[116:117], v49 offset:36928
    ds_read_b64_tr_b16 v[118:119], v49 offset:37440
    ds_read_b64_tr_b16 v[120:121], v49 offset:32864
    ds_read_b64_tr_b16 v[122:123], v49 offset:33376
    ds_read_b64_tr_b16 v[124:125], v49 offset:36960
    ds_read_b64_tr_b16 v[126:127], v49 offset:37472
    ds_read_b64_tr_b16 v[128:129], v48 offset:0
    ds_read_b64_tr_b16 v[130:131], v48 offset:512
    ds_read_b64_tr_b16 v[132:133], v48 offset:4096
    ds_read_b64_tr_b16 v[134:135], v48 offset:4608
    ds_read_b64_tr_b16 v[136:137], v48 offset:32
    ds_read_b64_tr_b16 v[138:139], v48 offset:544
    ds_read_b64_tr_b16 v[140:141], v48 offset:4128
    ds_read_b64_tr_b16 v[142:143], v48 offset:4640
    ds_read_b64_tr_b16 v[144:145], v48 offset:64
    ds_read_b64_tr_b16 v[146:147], v48 offset:576
    ds_read_b64_tr_b16 v[148:149], v48 offset:4160
    ds_read_b64_tr_b16 v[150:151], v48 offset:4672
    ds_read_b64_tr_b16 v[152:153], v48 offset:96
    ds_read_b64_tr_b16 v[154:155], v48 offset:608
    ds_read_b64_tr_b16 v[156:157], v48 offset:4192
    ds_read_b64_tr_b16 v[158:159], v48 offset:4704
    s_waitcnt lgkmcnt(0)
    v_mfma_f32_16x16x32_bf16 v[208:211], v[96:99], v[16:19], 0
    v_mfma_f32_16x16x32_bf16 v[212:215], v[104:107], v[16:19], 0
    v_mfma_f32_16x16x32_bf16 v[216:219], v[112:115], v[16:19], 0
    v_mfma_f32_16x16x32_bf16 v[220:223], v[120:123], v[16:19], 0
    v_mfma_f32_16x16x32_bf16 v[208:211], v[100:103], v[20:23], v[208:211]
    v_mfma_f32_16x16x32_bf16 v[212:215], v[108:111], v[20:23], v[212:215]
    v_mfma_f32_16x16x32_bf16 v[216:219], v[116:119], v[20:23], v[216:219]
    v_mfma_f32_16x16x32_bf16 v[220:223], v[124:127], v[20:23], v[220:223]
    s_nop 5
    v_cndmask_b32 v24, v208, v212, s[4:5]
    v_cndmask_b32 v25, v209, v213, s[4:5]
    v_cndmask_b32 v26, v210, v214, s[4:5]
    v_cndmask_b32 v27, v211, v215, s[4:5]
    v_cndmask_b32 v28, v216, v220, s[4:5]
    v_cndmask_b32 v29, v217, v221, s[4:5]
    v_cndmask_b32 v30, v218, v222, s[4:5]
    v_cndmask_b32 v31, v219, v223, s[4:5]
    ds_write_b128 v11, v[24:27] offset:32768
    ds_write_b128 v11, v[28:31] offset:33792
    v_mfma_f32_16x16x32_bf16 v[208:211], v[128:131], v[16:19], 0
    v_mfma_f32_16x16x32_bf16 v[212:215], v[136:139], v[16:19], 0
    v_mfma_f32_16x16x32_bf16 v[216:219], v[144:147], v[16:19], 0
    v_mfma_f32_16x16x32_bf16 v[220:223], v[152:155], v[16:19], 0
    v_mfma_f32_16x16x32_bf16 v[208:211], v[132:135], v[20:23], v[208:211]
    v_mfma_f32_16x16x32_bf16 v[212:215], v[140:143], v[20:23], v[212:215]
    v_mfma_f32_16x16x32_bf16 v[216:219], v[148:151], v[20:23], v[216:219]
    v_mfma_f32_16x16x32_bf16 v[220:223], v[156:159], v[20:23], v[220:223]
    s_nop 5
    v_cndmask_b32 v24, v208, v212, s[4:5]
    v_cndmask_b32 v25, v209, v213, s[4:5]
    v_cndmask_b32 v26, v210, v214, s[4:5]
    v_cndmask_b32 v27, v211, v215, s[4:5]
    v_cndmask_b32 v28, v216, v220, s[4:5]
    v_cndmask_b32 v29, v217, v221, s[4:5]
    v_cndmask_b32 v30, v218, v222, s[4:5]
    v_cndmask_b32 v31, v219, v223, s[4:5]
    ds_write_b128 v45, v[24:27] offset:0
    ds_write_b128 v45, v[28:31] offset:1024
    s_mov_b32 s84, 0
    s_mov_b64 exec, 1
    s_waitcnt lgkmcnt(0)
    ds_add_rtn_u32 v62, v60, v61 offset:260
    s_waitcnt lgkmcnt(0)
    v_readfirstlane_b32 s12, v62
    s_mov_b64 exec, -1
    s_cmp_lg_u32 s12, 3
    s_cbranch_scc1 L_a6
    ds_read_b128 v[96:99], v50 offset:32768
    ds_read_b128 v[100:103], v50 offset:33792
    ds_read_b128 v[104:107], v50 offset:40960
    ds_read_b128 v[108:111], v50 offset:41984
    ds_read_b128 v[112:115], v50 offset:49152
    ds_read_b128 v[116:119], v50 offset:50176
    ds_read_b128 v[120:123], v50 offset:57344
    ds_read_b128 v[124:127], v50 offset:58368
    ds_read_b128 v[128:131], v51 offset:0
    ds_read_b128 v[132:135], v51 offset:1024
    ds_read_b128 v[136:139], v51 offset:8192
    ds_read_b128 v[140:143], v51 offset:9216
    ds_read_b128 v[144:147], v51 offset:16384
    ds_read_b128 v[148:151], v51 offset:17408
    ds_read_b128 v[152:155], v51 offset:24576
    ds_read_b128 v[156:159], v51 offset:25600
    s_waitcnt lgkmcnt(0)
    v_add_f32 v96, v96, v104
    v_add_f32 v112, v112, v120
    v_add_f32 v97, v97, v105
    v_add_f32 v113, v113, v121
    v_add_f32 v98, v98, v106
    v_add_f32 v114, v114, v122
    v_add_f32 v99, v99, v107
    v_add_f32 v115, v115, v123
    v_add_f32 v100, v100, v108
    v_add_f32 v116, v116, v124
    v_add_f32 v101, v101, v109
    v_add_f32 v117, v117, v125
    v_add_f32 v102, v102, v110
    v_add_f32 v118, v118, v126
    v_add_f32 v103, v103, v111
    v_add_f32 v119, v119, v127
    v_add_f32 v96, v96, v112
    v_add_f32 v97, v97, v113
    v_add_f32 v98, v98, v114
    v_add_f32 v99, v99, v115
    v_add_f32 v100, v100, v116
    v_add_f32 v101, v101, v117
    v_add_f32 v102, v102, v118
    v_add_f32 v103, v103, v119
    v_min_u32 v96, -2, v96
    v_min_u32 v97, -2, v97
    v_min_u32 v98, -2, v98
    v_min_u32 v99, -2, v99
    v_min_u32 v100, -2, v100
    v_min_u32 v101, -2, v101
    v_min_u32 v102, -2, v102
    v_min_u32 v103, -2, v103
    v_add_f32 v128, v128, v136
    v_add_f32 v144, v144, v152
    v_add_f32 v129, v129, v137
    v_add_f32 v145, v145, v153
    v_add_f32 v130, v130, v138
    v_add_f32 v146, v146, v154
    v_add_f32 v131, v131, v139
    v_add_f32 v147, v147, v155
    v_add_f32 v132, v132, v140
    v_add_f32 v148, v148, v156
    v_add_f32 v133, v133, v141
    v_add_f32 v149, v149, v157
    v_add_f32 v134, v134, v142
    v_add_f32 v150, v150, v158
    v_add_f32 v135, v135, v143
    v_add_f32 v151, v151, v159
    v_add_f32 v128, v128, v144
    v_add_f32 v129, v129, v145
    v_add_f32 v130, v130, v146
    v_add_f32 v131, v131, v147
    v_add_f32 v132, v132, v148
    v_add_f32 v133, v133, v149
    v_add_f32 v134, v134, v150
    v_add_f32 v135, v135, v151
    v_min_u32 v128, -2, v128
    v_min_u32 v129, -2, v129
    v_min_u32 v130, -2, v130
    v_min_u32 v131, -2, v131
    v_min_u32 v132, -2, v132
    v_min_u32 v133, -2, v133
    v_min_u32 v134, -2, v134
    v_min_u32 v135, -2, v135
    buffer_store_dwordx4 v[96:99], v40, s[20:23], s28 offen offset:0 sc1
    buffer_store_dwordx4 v[100:103], v40, s[20:23], s28 offen offset:1024 sc1
    buffer_store_dwordx4 v[128:131], v40, s[20:23], s28 offen offset:2048 sc1
    buffer_store_dwordx4 v[132:135], v40, s[20:23], s28 offen offset:3072 sc1
    s_mov_b32 s84, 1
L_a6:
    s_waitcnt vmcnt(0)
    ds_read_b64_tr_b16 v[160:161], v49 offset:0
    ds_read_b64_tr_b16 v[162:163], v49 offset:512
    ds_read_b64_tr_b16 v[164:165], v49 offset:4096
    ds_read_b64_tr_b16 v[166:167], v49 offset:4608
    ds_read_b64_tr_b16 v[168:169], v49 offset:32
    ds_read_b64_tr_b16 v[170:171], v49 offset:544
    ds_read_b64_tr_b16 v[172:173], v49 offset:4128
    ds_read_b64_tr_b16 v[174:175], v49 offset:4640
    ds_read_b64_tr_b16 v[176:177], v49 offset:64
    ds_read_b64_tr_b16 v[178:179], v49 offset:576
    ds_read_b64_tr_b16 v[180:181], v49 offset:4160
    ds_read_b64_tr_b16 v[182:183], v49 offset:4672
    ds_read_b64_tr_b16 v[184:185], v49 offset:96
    ds_read_b64_tr_b16 v[186:187], v49 offset:608
    ds_read_b64_tr_b16 v[188:189], v49 offset:4192
    ds_read_b64_tr_b16 v[190:191], v49 offset:4704
    ds_read_b64_tr_b16 v[64:65], v48 offset:32768
    ds_read_b64_tr_b16 v[66:67], v48 offset:33280
    ds_read_b64_tr_b16 v[68:69], v48 offset:36864
    ds_read_b64_tr_b16 v[70:71], v48 offset:37376
    ds_read_b64_tr_b16 v[72:73], v48 offset:32800
    ds_read_b64_tr_b16 v[74:75], v48 offset:33312
    ds_read_b64_tr_b16 v[76:77], v48 offset:36896
    ds_read_b64_tr_b16 v[78:79], v48 offset:37408
    ds_read_b64_tr_b16 v[80:81], v48 offset:32832
    ds_read_b64_tr_b16 v[82:83], v48 offset:33344
    ds_read_b64_tr_b16 v[84:85], v48 offset:36928
    ds_read_b64_tr_b16 v[86:87], v48 offset:37440
    ds_read_b64_tr_b16 v[88:89], v48 offset:32864
    ds_read_b64_tr_b16 v[90:91], v48 offset:33376
    ds_read_b64_tr_b16 v[92:93], v48 offset:36960
    ds_read_b64_tr_b16 v[94:95], v48 offset:37472
    s_mov_b32 s60, s36
    s_mov_b32 s61, s37
    s_mov_b32 s62, 0x4000
    s_mov_b32 s63, 0x00020000
    v_mov_b32 v44, 0
    v_lshlrev_b32 v60, 16, v192
    v_and_b32 v61, s8, v192
    v_lshlrev_b32 v62, 16, v200
    v_and_b32 v63, s8, v200
    v_mul_f32 v60, v60, v62
    v_mul_f32 v61, v61, v63
    v_cvt_pk_bf16_f32 v60, v60, v61
    v_lshlrev_b32 v61, 16, v60
    v_and_b32 v60, s8, v60
    v_add_f32 v44, v44, v61
    v_add_f32 v44, v44, v60
    v_lshlrev_b32 v60, 16, v193
    v_and_b32 v61, s8, v193
    v_lshlrev_b32 v62, 16, v201
    v_and_b32 v63, s8, v201
    v_mul_f32 v60, v60, v62
    v_mul_f32 v61, v61, v63
    v_cvt_pk_bf16_f32 v60, v60, v61
    v_lshlrev_b32 v61, 16, v60
    v_and_b32 v60, s8, v60
    v_add_f32 v44, v44, v61
    v_add_f32 v44, v44, v60
    v_lshlrev_b32 v60, 16, v194
    v_and_b32 v61, s8, v194
    v_lshlrev_b32 v62, 16, v202
    v_and_b32 v63, s8, v202
    v_mul_f32 v60, v60, v62
    v_mul_f32 v61, v61, v63
    v_cvt_pk_bf16_f32 v60, v60, v61
    v_lshlrev_b32 v61, 16, v60
    v_and_b32 v60, s8, v60
    v_add_f32 v44, v44, v61
    v_add_f32 v44, v44, v60
    v_lshlrev_b32 v60, 16, v195
    v_and_b32 v61, s8, v195
    v_lshlrev_b32 v62, 16, v203
    v_and_b32 v63, s8, v203
    v_mul_f32 v60, v60, v62
    v_mul_f32 v61, v61, v63
    v_cvt_pk_bf16_f32 v60, v60, v61
    v_lshlrev_b32 v61, 16, v60
    v_and_b32 v60, s8, v60
    v_add_f32 v44, v44, v61
    v_add_f32 v44, v44, v60
    v_lshlrev_b32 v60, 16, v196
    v_and_b32 v61, s8, v196
    v_lshlrev_b32 v62, 16, v204
    v_and_b32 v63, s8, v204
    v_mul_f32 v60, v60, v62
    v_mul_f32 v61, v61, v63
    v_cvt_pk_bf16_f32 v60, v60, v61
    v_lshlrev_b32 v61, 16, v60
    v_and_b32 v60, s8, v60
    v_add_f32 v44, v44, v61
    v_add_f32 v44, v44, v60
    v_lshlrev_b32 v60, 16, v197
    v_and_b32 v61, s8, v197
    v_lshlrev_b32 v62, 16, v205
    v_and_b32 v63, s8, v205
    v_mul_f32 v60, v60, v62
    v_mul_f32 v61, v61, v63
    v_cvt_pk_bf16_f32 v60, v60, v61
    v_lshlrev_b32 v61, 16, v60
    v_and_b32 v60, s8, v60
    v_add_f32 v44, v44, v61
    v_add_f32 v44, v44, v60
    v_lshlrev_b32 v60, 16, v198
    v_and_b32 v61, s8, v198
    v_lshlrev_b32 v62, 16, v206
    v_and_b32 v63, s8, v206
    v_mul_f32 v60, v60, v62
    v_mul_f32 v61, v61, v63
    v_cvt_pk_bf16_f32 v60, v60, v61
    v_lshlrev_b32 v61, 16, v60
    v_and_b32 v60, s8, v60
    v_add_f32 v44, v44, v61
    v_add_f32 v44, v44, v60
    v_lshlrev_b32 v60, 16, v199
    v_and_b32 v61, s8, v199
    v_lshlrev_b32 v62, 16, v207
    v_and_b32 v63, s8, v207
    v_mul_f32 v60, v60, v62
    v_mul_f32 v61, v61, v63
    v_cvt_pk_bf16_f32 v60, v60, v61
    v_lshlrev_b32 v61, 16, v60
    v_and_b32 v60, s8, v60
    v_add_f32 v44, v44, v61
    v_add_f32 v44, v44, v60
    s_nop 1
    v_add_f32_dpp v44, v44, v44 row_ror:8 row_mask:0xf bank_mask:0xf
    s_nop 1
    v_add_f32_dpp v44, v44, v44 row_ror:4 row_mask:0xf bank_mask:0xf
    s_nop 1
    v_add_f32_dpp v44, v44, v44 row_ror:2 row_mask:0xf bank_mask:0xf
    s_nop 1
    v_add_f32_dpp v44, v44, v44 row_ror:1 row_mask:0xf bank_mask:0xf
    v_mov_b32 v60, v44
    s_nop 1
    v_permlane32_swap_b32 v44, v60
    v_add_f32 v44, v44, v60
    v_mov_b32 v60, v44
    s_nop 1
    v_permlane16_swap_b32 v44, v60
    v_add_f32 v44, v44, v60
    v_cvt_pk_bf16_f32 v60, v44, v44
    v_and_b32 v44, s8, v60
    s_mov_b32 s10, 0xbfb8aa3b
    v_mul_f32 v44, s10, v44
    v_exp_f32 v44, v44
    s_nop 0
    v_add_f32 v44, 1.0, v44
    v_rcp_f32 v44, v44
    s_nop 0
    v_cvt_pk_bf16_f32 v60, v44, v44
    v_and_b32 v44, s8, v60
    v_sub_f32 v60, 1.0, v44
    v_cvt_pk_bf16_f32 v61, v60, v60
    v_and_b32 v60, s8, v61
    v_cndmask_b32 v44, v44, v60, s[4:5]
    v_mov_b32 v60, 0
L_mbok:
    ds_read_b32 v62, v60 offset:256
    s_waitcnt lgkmcnt(0)
    v_readfirstlane_b32 s12, v62
    s_nop 1
    s_cmp_eq_u32 s12, 4
    s_cbranch_scc1 L_mbok_done
    s_sleep 8
    s_branch L_mbok
L_mbok_done:
    s_mov_b32 s12, 0
L_go2:
    buffer_load_dword v62, off, s[52:55], s86 offset:4 sc1
    s_waitcnt vmcnt(0)
    v_readfirstlane_b32 s10, v62
    s_nop 1
    s_cmp_lg_u32 s10, 0
    s_cbranch_scc1 L_go2_done
    s_sleep 127
    s_add_u32 s12, s12, 1
    s_cmp_lt_u32 s12, 5000
    s_cbranch_scc1 L_go2
L_go2_done:
    s_cmp_eq_u32 s84, 0
    s_cbranch_scc1 L_a6b
    s_add_u32 s13, s26, 0
    s_mov_b32 s12, 0
L_pollG0:
    buffer_load_dwordx4 v[192:195], v40, s[16:19], s13 offen offset:0 sc1
    buffer_load_dwordx4 v[196:199], v40, s[16:19], s13 offen offset:1024 sc1
    buffer_load_dwordx4 v[200:203], v40, s[16:19], s13 offen offset:2048 sc1
    buffer_load_dwordx4 v[204:207], v40, s[16:19], s13 offen offset:3072 sc1
    s_waitcnt vmcnt(0)
    v_max3_u32 v60, v192, v193, v194
    v_max3_u32 v61, v195, v196, v197
    v_max3_u32 v62, v198, v199, v200
    v_max3_u32 v63, v201, v202, v203
    v_max3_u32 v60, v60, v204, v205
    v_max3_u32 v61, v61, v206, v207
    v_max3_u32 v60, v60, v61, v62
    v_max_u32 v60, v60, v63
    v_cmp_eq_u32 vcc, -1, v60
    s_cbranch_vccz L_pollG0_done
    s_mov_b64 exec, vcc
    s_sleep 127
    s_add_u32 s12, s12, 1
    s_cmp_lt_u32 s12, 5000
    s_cbranch_scc1 L_pollG0
L_pollG0_done:
    s_mov_b64 exec, -1
    v_add_f32 v96, v96, v192
    v_add_f32 v128, v128, v200
    v_add_f32 v97, v97, v193
    v_add_f32 v129, v129, v201
    v_add_f32 v98, v98, v194
    v_add_f32 v130, v130, v202
    v_add_f32 v99, v99, v195
    v_add_f32 v131, v131, v203
    v_add_f32 v100, v100, v196
    v_add_f32 v132, v132, v204
    v_add_f32 v101, v101, v197
    v_add_f32 v133, v133, v205
    v_add_f32 v102, v102, v198
    v_add_f32 v134, v134, v206
    v_add_f32 v103, v103, v199
    v_add_f32 v135, v135, v207
    s_add_u32 s13, s26, 4096
    s_mov_b32 s12, 0
L_pollG1:
    buffer_load_dwordx4 v[192:195], v40, s[16:19], s13 offen offset:0 sc1
    buffer_load_dwordx4 v[196:199], v40, s[16:19], s13 offen offset:1024 sc1
    buffer_load_dwordx4 v[200:203], v40, s[16:19], s13 offen offset:2048 sc1
    buffer_load_dwordx4 v[204:207], v40, s[16:19], s13 offen offset:3072 sc1
    s_waitcnt vmcnt(0)
    v_max3_u32 v60, v192, v193, v194
    v_max3_u32 v61, v195, v196, v197
    v_max3_u32 v62, v198, v199, v200
    v_max3_u32 v63, v201, v202, v203
    v_max3_u32 v60, v60, v204, v205
    v_max3_u32 v61, v61, v206, v207
    v_max3_u32 v60, v60, v61, v62
    v_max_u32 v60, v60, v63
    v_cmp_eq_u32 vcc, -1, v60
    s_cbranch_vccz L_pollG1_done
    s_mov_b64 exec, vcc
    s_sleep 127
    s_add_u32 s12, s12, 1
    s_cmp_lt_u32 s12, 5000
    s_cbranch_scc1 L_pollG1
L_pollG1_done:
    s_mov_b64 exec, -1
    v_add_f32 v96, v96, v192
    v_add_f32 v128, v128, v200
    v_add_f32 v97, v97, v193
    v_add_f32 v129, v129, v201
    v_add_f32 v98, v98, v194
    v_add_f32 v130, v130, v202
    v_add_f32 v99, v99, v195
    v_add_f32 v131, v131, v203
    v_add_f32 v100, v100, v196
    v_add_f32 v132, v132, v204
    v_add_f32 v101, v101, v197
    v_add_f32 v133, v133, v205
    v_add_f32 v102, v102, v198
    v_add_f32 v134, v134, v206
    v_add_f32 v103, v103, v199
    v_add_f32 v135, v135, v207
    s_add_u32 s13, s26, 8192
    s_mov_b32 s12, 0
L_pollG2:
    buffer_load_dwordx4 v[192:195], v40, s[16:19], s13 offen offset:0 sc1
    buffer_load_dwordx4 v[196:199], v40, s[16:19], s13 offen offset:1024 sc1
    buffer_load_dwordx4 v[200:203], v40, s[16:19], s13 offen offset:2048 sc1
    buffer_load_dwordx4 v[204:207], v40, s[16:19], s13 offen offset:3072 sc1
    s_waitcnt vmcnt(0)
    v_max3_u32 v60, v192, v193, v194
    v_max3_u32 v61, v195, v196, v197
    v_max3_u32 v62, v198, v199, v200
    v_max3_u32 v63, v201, v202, v203
    v_max3_u32 v60, v60, v204, v205
    v_max3_u32 v61, v61, v206, v207
    v_max3_u32 v60, v60, v61, v62
    v_max_u32 v60, v60, v63
    v_cmp_eq_u32 vcc, -1, v60
    s_cbranch_vccz L_pollG2_done
    s_mov_b64 exec, vcc
    s_sleep 127
    s_add_u32 s12, s12, 1
    s_cmp_lt_u32 s12, 5000
    s_cbranch_scc1 L_pollG2
L_pollG2_done:
    s_mov_b64 exec, -1
    v_add_f32 v96, v96, v192
    v_add_f32 v128, v128, v200
    v_add_f32 v97, v97, v193
    v_add_f32 v129, v129, v201
    v_add_f32 v98, v98, v194
    v_add_f32 v130, v130, v202
    v_add_f32 v99, v99, v195
    v_add_f32 v131, v131, v203
    v_add_f32 v100, v100, v196
    v_add_f32 v132, v132, v204
    v_add_f32 v101, v101, v197
    v_add_f32 v133, v133, v205
    v_add_f32 v102, v102, v198
    v_add_f32 v134, v134, v206
    v_add_f32 v103, v103, v199
    v_add_f32 v135, v135, v207
    v_cvt_pk_bf16_f32 v104, v96, v97
    v_cvt_pk_bf16_f32 v108, v128, v129
    v_cvt_pk_bf16_f32 v105, v98, v99
    v_cvt_pk_bf16_f32 v109, v130, v131
    v_cvt_pk_bf16_f32 v106, v100, v101
    v_cvt_pk_bf16_f32 v110, v132, v133
    v_cvt_pk_bf16_f32 v107, v102, v103
    v_cvt_pk_bf16_f32 v111, v134, v135
    v_lshlrev_b32 v96, 16, v104
    v_and_b32 v97, s8, v104
    v_lshlrev_b32 v128, 16, v108
    v_and_b32 v129, s8, v108
    v_lshlrev_b32 v98, 16, v105
    v_and_b32 v99, s8, v105
    v_lshlrev_b32 v130, 16, v109
    v_and_b32 v131, s8, v109
    v_lshlrev_b32 v100, 16, v106
    v_and_b32 v101, s8, v106
    v_lshlrev_b32 v132, 16, v110
    v_and_b32 v133, s8, v110
    v_lshlrev_b32 v102, 16, v107
    v_and_b32 v103, s8, v107
    v_lshlrev_b32 v134, 16, v111
    v_and_b32 v135, s8, v111
    s_mov_b32 s10, 0x3d372713
    s_mov_b32 s11, 0xc0135761
    v_mul_f32 v104, v96, v96
    v_mul_f32 v105, v97, v97
    v_mul_f32 v106, v98, v98
    v_mul_f32 v107, v99, v99
    v_mul_f32 v108, v100, v100
    v_mul_f32 v109, v101, v101
    v_mul_f32 v110, v102, v102
    v_mul_f32 v111, v103, v103
    v_fma_f32 v104, v104, s10, 1.0
    v_fma_f32 v105, v105, s10, 1.0
    v_fma_f32 v106, v106, s10, 1.0
    v_fma_f32 v107, v107, s10, 1.0
    v_fma_f32 v108, v108, s10, 1.0
    v_fma_f32 v109, v109, s10, 1.0
    v_fma_f32 v110, v110, s10, 1.0
    v_fma_f32 v111, v111, s10, 1.0
    v_mul_f32 v104, v104, v96
    v_mul_f32 v105, v105, v97
    v_mul_f32 v106, v106, v98
    v_mul_f32 v107, v107, v99
    v_mul_f32 v108, v108, v100
    v_mul_f32 v109, v109, v101
    v_mul_f32 v110, v110, v102
    v_mul_f32 v111, v111, v103
    v_mul_f32 v104, s11, v104
    v_mul_f32 v105, s11, v105
    v_mul_f32 v106, s11, v106
    v_mul_f32 v107, s11, v107
    v_mul_f32 v108, s11, v108
    v_mul_f32 v109, s11, v109
    v_mul_f32 v110, s11, v110
    v_mul_f32 v111, s11, v111
    v_exp_f32 v104, v104
    v_exp_f32 v105, v105
    v_exp_f32 v106, v106
    v_exp_f32 v107, v107
    v_exp_f32 v108, v108
    v_exp_f32 v109, v109
    v_exp_f32 v110, v110
    v_exp_f32 v111, v111
    v_add_f32 v104, 1.0, v104
    v_add_f32 v105, 1.0, v105
    v_add_f32 v106, 1.0, v106
    v_add_f32 v107, 1.0, v107
    v_add_f32 v108, 1.0, v108
    v_add_f32 v109, 1.0, v109
    v_add_f32 v110, 1.0, v110
    v_add_f32 v111, 1.0, v111
    v_rcp_f32 v104, v104
    v_rcp_f32 v105, v105
    v_rcp_f32 v106, v106
    v_rcp_f32 v107, v107
    v_rcp_f32 v108, v108
    v_rcp_f32 v109, v109
    v_rcp_f32 v110, v110
    v_rcp_f32 v111, v111
    v_mul_f32 v96, v96, v104
    v_mul_f32 v97, v97, v105
    v_mul_f32 v98, v98, v106
    v_mul_f32 v99, v99, v107
    v_mul_f32 v100, v100, v108
    v_mul_f32 v101, v101, v109
    v_mul_f32 v102, v102, v110
    v_mul_f32 v103, v103, v111
    v_cvt_pk_bf16_f32 v104, v96, v97
    v_cvt_pk_bf16_f32 v105, v98, v99
    v_cvt_pk_bf16_f32 v106, v100, v101
    v_cvt_pk_bf16_f32 v107, v102, v103
    v_lshlrev_b32 v96, 16, v104
    v_and_b32 v97, s8, v104
    v_lshlrev_b32 v98, 16, v105
    v_and_b32 v99, s8, v105
    v_lshlrev_b32 v100, 16, v106
    v_and_b32 v101, s8, v106
    v_lshlrev_b32 v102, 16, v107
    v_and_b32 v103, s8, v107
    v_mul_f32 v96, v96, v128
    v_mul_f32 v97, v97, v129
    v_mul_f32 v98, v98, v130
    v_mul_f32 v99, v99, v131
    v_mul_f32 v100, v100, v132
    v_mul_f32 v101, v101, v133
    v_mul_f32 v102, v102, v134
    v_mul_f32 v103, v103, v135
    v_cvt_pk_bf16_f32 v32, v96, v97
    v_cvt_pk_bf16_f32 v33, v98, v99
    v_cvt_pk_bf16_f32 v34, v100, v101
    v_cvt_pk_bf16_f32 v35, v102, v103
    v_min_u32 v32, -2, v32
    v_min_u32 v33, -2, v33
    v_min_u32 v34, -2, v34
    v_min_u32 v35, -2, v35
    buffer_store_dwordx2 v[32:33], v47, s[16:19], s87 offen sc1
    buffer_store_dwordx2 v[34:35], v47, s[16:19], s87 offen offset:64 sc1
L_a6b:
    s_mov_b32 s12, 0
L_pollH:
    buffer_load_dwordx4 v[192:195], v15, s[72:75], s85 offen offset:0 sc1
    buffer_load_dwordx4 v[196:199], v15, s[72:75], s85 offen offset:64 sc1
    s_waitcnt vmcnt(0)
    v_max3_u32 v60, v192, v193, v194
    v_max3_u32 v61, v195, v196, v197
    v_max3_u32 v60, v60, v198, v199
    v_max_u32 v60, v60, v61
    v_cmp_eq_u32 vcc, -1, v60
    s_cbranch_vccz L_pollH_done
    s_mov_b64 exec, vcc
    s_sleep 127
    s_add_u32 s12, s12, 1
    s_cmp_lt_u32 s12, 5000
    s_cbranch_scc1 L_pollH
L_pollH_done:
    s_mov_b64 exec, -1
    s_waitcnt lgkmcnt(0)
    s_nop 2
    v_mfma_f32_16x16x32_bf16 v[208:211], v[64:67], v[192:195], 0
    v_mfma_f32_16x16x32_bf16 v[212:215], v[72:75], v[192:195], 0
    v_mfma_f32_16x16x32_bf16 v[216:219], v[80:83], v[192:195], 0
    v_mfma_f32_16x16x32_bf16 v[220:223], v[88:91], v[192:195], 0
    v_mfma_f32_16x16x32_bf16 v[208:211], v[68:71], v[196:199], v[208:211]
    v_mfma_f32_16x16x32_bf16 v[212:215], v[76:79], v[196:199], v[212:215]
    v_mfma_f32_16x16x32_bf16 v[216:219], v[84:87], v[196:199], v[216:219]
    v_mfma_f32_16x16x32_bf16 v[220:223], v[92:95], v[196:199], v[220:223]
    s_nop 5
    v_cndmask_b32 v24, v208, v212, s[4:5]
    v_cndmask_b32 v25, v209, v213, s[4:5]
    v_cndmask_b32 v26, v210, v214, s[4:5]
    v_cndmask_b32 v27, v211, v215, s[4:5]
    v_cndmask_b32 v28, v216, v220, s[4:5]
    v_cndmask_b32 v29, v217, v221, s[4:5]
    v_cndmask_b32 v30, v218, v222, s[4:5]
    v_cndmask_b32 v31, v219, v223, s[4:5]
    ds_write_b128 v45, v[24:27] offset:32768
    ds_write_b128 v45, v[28:31] offset:33792
    s_mov_b32 s10, 0x3fb8aa3b
    s_setprio 3
    s_waitcnt lgkmcnt(0)
    s_barrier
    s_cmp_lg_u32 s9, 0
    s_cbranch_scc1 L_gatherO
    ds_read_b64 v[60:61], v43 offset:512
    ds_read_b64 v[96:97], v0 offset:4096
    ds_read_b64 v[98:99], v0 offset:4608
    ds_read_b64 v[100:101], v0 offset:5120
    ds_read_b64 v[102:103], v0 offset:5632
    ds_read_b64 v[104:105], v0 offset:6144
    ds_read_b64 v[106:107], v0 offset:6656
    ds_read_b64 v[108:109], v0 offset:7168
    ds_read_b64 v[110:111], v0 offset:7680
    ds_read_b64 v[112:113], v0 offset:8192
    ds_read_b64 v[114:115], v0 offset:8704
    ds_read_b64 v[116:117], v0 offset:9216
    ds_read_b64 v[118:119], v0 offset:9728
    ds_read_b64 v[120:121], v0 offset:10240
    ds_read_b64 v[122:123], v0 offset:10752
    ds_read_b64 v[124:125], v0 offset:11264
    ds_read_b64 v[126:127], v0 offset:11776
    s_waitcnt lgkmcnt(15)
    v_max_f32_dpp v62, v60, v60 row_ror:8 row_mask:0xf bank_mask:0xf
    s_nop 1
    v_max_f32_dpp v62, v62, v62 row_ror:4 row_mask:0xf bank_mask:0xf
    s_nop 1
    v_max_f32_dpp v62, v62, v62 row_ror:2 row_mask:0xf bank_mask:0xf
    s_nop 1
    v_max_f32_dpp v62, v62, v62 row_ror:1 row_mask:0xf bank_mask:0xf
    v_sub_f32 v60, v60, v62
    v_mul_f32 v60, s10, v60
    v_exp_f32 v60, v60
    s_nop 0
    v_mul_f32 v61, v61, v60
    s_nop 1
    v_add_f32_dpp v61, v61, v61 row_ror:8 row_mask:0xf bank_mask:0xf
    s_nop 1
    v_add_f32_dpp v61, v61, v61 row_ror:4 row_mask:0xf bank_mask:0xf
    s_nop 1
    v_add_f32_dpp v61, v61, v61 row_ror:2 row_mask:0xf bank_mask:0xf
    s_nop 1
    v_add_f32_dpp v61, v61, v61 row_ror:1 row_mask:0xf bank_mask:0xf
    v_rcp_f32 v61, v61
    s_nop 0
    v_mul_f32 v60, v60, v61
    s_waitcnt lgkmcnt(0)
    s_nop 0
    v_mul_f32_dpp v62, v60, v96 row_newbcast:0 row_mask:0xf bank_mask:0xf
    v_mul_f32_dpp v63, v60, v97 row_newbcast:0 row_mask:0xf bank_mask:0xf
    v_fmac_f32_dpp v62, v60, v98 row_newbcast:1 row_mask:0xf bank_mask:0xf
    v_fmac_f32_dpp v63, v60, v99 row_newbcast:1 row_mask:0xf bank_mask:0xf
    v_fmac_f32_dpp v62, v60, v100 row_newbcast:2 row_mask:0xf bank_mask:0xf
    v_fmac_f32_dpp v63, v60, v101 row_newbcast:2 row_mask:0xf bank_mask:0xf
    v_fmac_f32_dpp v62, v60, v102 row_newbcast:3 row_mask:0xf bank_mask:0xf
    v_fmac_f32_dpp v63, v60, v103 row_newbcast:3 row_mask:0xf bank_mask:0xf
    v_fmac_f32_dpp v62, v60, v104 row_newbcast:4 row_mask:0xf bank_mask:0xf
    v_fmac_f32_dpp v63, v60, v105 row_newbcast:4 row_mask:0xf bank_mask:0xf
    v_fmac_f32_dpp v62, v60, v106 row_newbcast:5 row_mask:0xf bank_mask:0xf
    v_fmac_f32_dpp v63, v60, v107 row_newbcast:5 row_mask:0xf bank_mask:0xf
    v_fmac_f32_dpp v62, v60, v108 row_newbcast:6 row_mask:0xf bank_mask:0xf
    v_fmac_f32_dpp v63, v60, v109 row_newbcast:6 row_mask:0xf bank_mask:0xf
    v_fmac_f32_dpp v62, v60, v110 row_newbcast:7 row_mask:0xf bank_mask:0xf
    v_fmac_f32_dpp v63, v60, v111 row_newbcast:7 row_mask:0xf bank_mask:0xf
    v_fmac_f32_dpp v62, v60, v112 row_newbcast:8 row_mask:0xf bank_mask:0xf
    v_fmac_f32_dpp v63, v60, v113 row_newbcast:8 row_mask:0xf bank_mask:0xf
    v_fmac_f32_dpp v62, v60, v114 row_newbcast:9 row_mask:0xf bank_mask:0xf
    v_fmac_f32_dpp v63, v60, v115 row_newbcast:9 row_mask:0xf bank_mask:0xf
    v_fmac_f32_dpp v62, v60, v116 row_newbcast:10 row_mask:0xf bank_mask:0xf
    v_fmac_f32_dpp v63, v60, v117 row_newbcast:10 row_mask:0xf bank_mask:0xf
    v_fmac_f32_dpp v62, v60, v118 row_newbcast:11 row_mask:0xf bank_mask:0xf
    v_fmac_f32_dpp v63, v60, v119 row_newbcast:11 row_mask:0xf bank_mask:0xf
    v_fmac_f32_dpp v62, v60, v120 row_newbcast:12 row_mask:0xf bank_mask:0xf
    v_fmac_f32_dpp v63, v60, v121 row_newbcast:12 row_mask:0xf bank_mask:0xf
    v_fmac_f32_dpp v62, v60, v122 row_newbcast:13 row_mask:0xf bank_mask:0xf
    v_fmac_f32_dpp v63, v60, v123 row_newbcast:13 row_mask:0xf bank_mask:0xf
    v_fmac_f32_dpp v62, v60, v124 row_newbcast:14 row_mask:0xf bank_mask:0xf
    v_fmac_f32_dpp v63, v60, v125 row_newbcast:14 row_mask:0xf bank_mask:0xf
    v_fmac_f32_dpp v62, v60, v126 row_newbcast:15 row_mask:0xf bank_mask:0xf
    v_fmac_f32_dpp v63, v60, v127 row_newbcast:15 row_mask:0xf bank_mask:0xf
    v_cvt_pk_bf16_f32 v62, v62, v63
    v_min_u32 v62, -2, v62
    buffer_store_dword v62, v8, s[52:55], s82 offen sc1
L_gatherO:
    s_cmp_lg_u32 s9, 3
    s_cbranch_scc1 L_a6c
    ds_read_b128 v[96:99], v51 offset:32768
    ds_read_b128 v[100:103], v51 offset:33792
    ds_read_b128 v[104:107], v51 offset:40960
    ds_read_b128 v[108:111], v51 offset:41984
    ds_read_b128 v[112:115], v51 offset:49152
    ds_read_b128 v[116:119], v51 offset:50176
    ds_read_b128 v[120:123], v51 offset:57344
    ds_read_b128 v[124:127], v51 offset:58368
    s_waitcnt lgkmcnt(0)
    v_add_f32 v96, v96, v104
    v_add_f32 v112, v112, v120
    v_add_f32 v97, v97, v105
    v_add_f32 v113, v113, v121
    v_add_f32 v98, v98, v106
    v_add_f32 v114, v114, v122
    v_add_f32 v99, v99, v107
    v_add_f32 v115, v115, v123
    v_add_f32 v100, v100, v108
    v_add_f32 v116, v116, v124
    v_add_f32 v101, v101, v109
    v_add_f32 v117, v117, v125
    v_add_f32 v102, v102, v110
    v_add_f32 v118, v118, v126
    v_add_f32 v103, v103, v111
    v_add_f32 v119, v119, v127
    v_add_f32 v96, v96, v112
    v_add_f32 v97, v97, v113
    v_add_f32 v98, v98, v114
    v_add_f32 v99, v99, v115
    v_add_f32 v100, v100, v116
    v_add_f32 v101, v101, v117
    v_add_f32 v102, v102, v118
    v_add_f32 v103, v103, v119
    v_min_u32 v96, -2, v96
    v_min_u32 v97, -2, v97
    v_min_u32 v98, -2, v98
    v_min_u32 v99, -2, v99
    v_min_u32 v100, -2, v100
    v_min_u32 v101, -2, v101
    v_min_u32 v102, -2, v102
    v_min_u32 v103, -2, v103
    buffer_store_dwordx4 v[96:99], v6, s[52:55], s80 offen offset:128 sc1
    buffer_store_dwordx4 v[100:103], v6, s[52:55], s30 offen offset:128 sc1
L_a6c:
    s_mov_b32 s12, 0
L_pollO:
    buffer_load_dwordx4 v[192:195], v14, s[52:55], s42 offen offset:0 sc1
    buffer_load_dwordx4 v[196:199], v14, s[52:55], s42 offen offset:64 sc1
    s_waitcnt vmcnt(0)
    v_max3_u32 v60, v192, v193, v194
    v_max3_u32 v61, v195, v196, v197
    v_max3_u32 v60, v60, v198, v199
    v_max_u32 v60, v60, v61
    v_cmp_eq_u32 vcc, -1, v60
    s_cbranch_vccz L_pollO_done
    s_mov_b64 exec, vcc
    s_add_u32 s12, s12, 1
    s_cmp_lt_u32 s12, 50000
    s_cbranch_scc1 L_pollO
L_pollO_done:
    s_mov_b64 exec, -1
    v_mov_b32 v60, 0
    v_mov_b32 v61, 1
    s_nop 1
    v_mfma_f32_16x16x32_bf16 v[208:211], v[160:163], v[192:195], 0
    v_mfma_f32_16x16x32_bf16 v[212:215], v[168:171], v[192:195], 0
    v_mfma_f32_16x16x32_bf16 v[216:219], v[176:179], v[192:195], 0
    v_mfma_f32_16x16x32_bf16 v[220:223], v[184:187], v[192:195], 0
    v_mfma_f32_16x16x32_bf16 v[208:211], v[164:167], v[196:199], v[208:211]
    v_mfma_f32_16x16x32_bf16 v[212:215], v[172:175], v[196:199], v[212:215]
    v_mfma_f32_16x16x32_bf16 v[216:219], v[180:183], v[196:199], v[216:219]
    v_mfma_f32_16x16x32_bf16 v[220:223], v[188:191], v[196:199], v[220:223]
    s_nop 5
    v_cndmask_b32 v24, v208, v212, s[4:5]
    v_cndmask_b32 v25, v209, v213, s[4:5]
    v_cndmask_b32 v26, v210, v214, s[4:5]
    v_cndmask_b32 v27, v211, v215, s[4:5]
    v_cndmask_b32 v28, v216, v220, s[4:5]
    v_cndmask_b32 v29, v217, v221, s[4:5]
    v_cndmask_b32 v30, v218, v222, s[4:5]
    v_cndmask_b32 v31, v219, v223, s[4:5]
    ds_write_b128 v11, v[24:27] offset:0
    ds_write_b128 v11, v[28:31] offset:1024
    s_mov_b64 exec, 1
    s_waitcnt lgkmcnt(0)
    ds_add_rtn_u32 v62, v60, v61 offset:268
    s_waitcnt lgkmcnt(0)
    v_readfirstlane_b32 s12, v62
    s_mov_b64 exec, -1
    s_cmp_lg_u32 s12, 3
    s_cbranch_scc1 L_a7
    ds_read_b128 v[96:99], v50 offset:0
    ds_read_b128 v[100:103], v50 offset:1024
    ds_read_b128 v[104:107], v50 offset:8192
    ds_read_b128 v[108:111], v50 offset:9216
    ds_read_b128 v[112:115], v50 offset:16384
    ds_read_b128 v[116:119], v50 offset:17408
    ds_read_b128 v[120:123], v50 offset:24576
    ds_read_b128 v[124:127], v50 offset:25600
    s_waitcnt lgkmcnt(0)
    v_add_f32 v96, v96, v104
    v_add_f32 v112, v112, v120
    v_add_f32 v97, v97, v105
    v_add_f32 v113, v113, v121
    v_add_f32 v98, v98, v106
    v_add_f32 v114, v114, v122
    v_add_f32 v99, v99, v107
    v_add_f32 v115, v115, v123
    v_add_f32 v100, v100, v108
    v_add_f32 v116, v116, v124
    v_add_f32 v101, v101, v109
    v_add_f32 v117, v117, v125
    v_add_f32 v102, v102, v110
    v_add_f32 v118, v118, v126
    v_add_f32 v103, v103, v111
    v_add_f32 v119, v119, v127
    v_add_f32 v96, v96, v112
    v_add_f32 v97, v97, v113
    v_add_f32 v98, v98, v114
    v_add_f32 v99, v99, v115
    v_add_f32 v100, v100, v116
    v_add_f32 v101, v101, v117
    v_add_f32 v102, v102, v118
    v_add_f32 v103, v103, v119
    v_min_u32 v96, -2, v96
    v_min_u32 v97, -2, v97
    v_min_u32 v98, -2, v98
    v_min_u32 v99, -2, v99
    v_min_u32 v100, -2, v100
    v_min_u32 v101, -2, v101
    v_min_u32 v102, -2, v102
    v_min_u32 v103, -2, v103
    buffer_store_dwordx4 v[96:99], v6, s[52:55], s80 offen sc1
    buffer_store_dwordx4 v[100:103], v6, s[52:55], s30 offen sc1
L_a7:
    s_cmp_lg_u32 s9, 0
    s_cbranch_scc1 L_fin
    s_mov_b32 s12, 0
L_pollA:
    buffer_load_dwordx4 v[64:67], v40, s[52:55], s14 offen offset:0 sc1
    buffer_load_dwordx4 v[68:71], v40, s[52:55], s14 offen offset:1024 sc1
    buffer_load_dwordx4 v[72:75], v40, s[52:55], s14 offen offset:2048 sc1
    buffer_load_dwordx4 v[76:79], v40, s[52:55], s14 offen offset:3072 sc1
    s_waitcnt vmcnt(0)
    v_max3_u32 v60, v64, v65, v66
    v_max3_u32 v61, v67, v68, v69
    v_max3_u32 v62, v70, v71, v72
    v_max3_u32 v63, v73, v74, v75
    v_max3_u32 v60, v60, v76, v77
    v_max3_u32 v61, v61, v78, v79
    v_max3_u32 v60, v60, v61, v62
    v_max_u32 v60, v60, v63
    v_cmp_eq_u32 vcc, -1, v60
    s_cbranch_vccz L_pollA_done
    s_mov_b64 exec, vcc
    s_add_u32 s12, s12, 1
    s_cmp_lt_u32 s12, 50000
    s_cbranch_scc1 L_pollA
L_pollA_done:
    s_mov_b64 exec, -1
    v_add_f32 v80, v64, v72
    v_add_f32 v81, v65, v73
    v_add_f32 v82, v66, v74
    v_add_f32 v83, v67, v75
    v_add_f32 v84, v68, v76
    v_add_f32 v85, v69, v77
    v_add_f32 v86, v70, v78
    v_add_f32 v87, v71, v79
    v_add_f32 v80, v80, v84
    v_add_f32 v81, v81, v85
    v_add_f32 v82, v82, v86
    v_add_f32 v83, v83, v87
    s_nop 0
    v_permlane32_swap_b32 v80, v82
    v_permlane32_swap_b32 v81, v83
    v_add_f32 v80, v80, v82
    v_add_f32 v81, v81, v83
    s_nop 1
    v_permlane16_swap_b32 v80, v81
    v_add_f32 v46, v80, v81
    v_cvt_pk_bf16_f32 v60, v46, v46
    v_and_b32 v46, s8, v60
    v_mul_f32 v46, v46, v44
    v_cvt_pk_bf16_f32 v60, v46, v46
    v_and_b32 v46, s8, v60
    s_nop 1
    v_add_f32_dpp v46, v46, v46 row_ror:8 row_mask:0xf bank_mask:0xf
    v_cvt_pk_bf16_f32 v46, v46, v46
    buffer_store_short v46, v42, s[60:63], s15 offen
L_fin:
L_end:
    s_endpgm
.section .rodata,"a"
.p2align 6
.amdhsa_kernel gated_mix__mha_block_cached__geglu_ffn__decode_kernel
  .amdhsa_next_free_vgpr 256
  .amdhsa_next_free_sgpr 102
  .amdhsa_accum_offset 256
  .amdhsa_group_segment_fixed_size 0
  .amdhsa_kernarg_size 104
  .amdhsa_user_sgpr_count 2
  .amdhsa_user_sgpr_kernarg_segment_ptr 1
  .amdhsa_system_sgpr_workgroup_id_x 1
  .amdhsa_float_denorm_mode_32 3
.end_amdhsa_kernel
```
